```python
import torch

def _softmax(x, axis=-1):
    return torch.softmax(x, dim=axis)
def _gelu(x):
    return torch.nn.functional.gelu(x, approximate="tanh")
def _silu(x):
    return torch.nn.functional.silu(x)
def _sigmoid(x):
    return torch.sigmoid(x)
def _layernorm(x, axis=-1, eps=1e-5):
    m = x.mean(dim=axis, keepdim=True)
    v = x.var(dim=axis, keepdim=True, unbiased=False)
    return (x - m) / torch.sqrt(v + eps)
def _scatter_add(tgt, idx, src, axis=0):
    return tgt.clone().index_add_(axis, idx, src)
def _segment_sum(src, seg, n):
    out = torch.zeros((n,) + src.shape[1:], dtype=src.dtype)
    return out.index_add_(0, seg, src)
def _pad(x, pw):
    flat = tuple(v for pair in reversed(pw) for v in pair)
    return torch.nn.functional.pad(x, flat)

kernel_name = 'standalone__molecular_angular_gemnet__graph'

def setup_inputs():

    _w = (lambda a: (lambda t: t.to(torch.bfloat16) if t.is_floating_point() else t)(torch.as_tensor(a)))
    N, deg, De, L = 10000, 32, 4, 1
    E = N * deg
    T = E * deg
    NR = 8
    dist = torch.rand(E).to(float)
    angle = (torch.rand(T) * torch.pi).to(float)
    centers = torch.linspace(0.0, 1.0, NR).to(float)
    ang_freq = torch.arange(1, L + 1).to(float)
    return {
        "m": _w((lambda *s: torch.randn(*s, dtype=torch.bfloat16) * 0.05)(E, De)),
        "idx_in": _w((lambda lo, hi, *s: torch.randint(lo, hi, s))(0, E, T).to(torch.int64)),
        "idx_out": _w((lambda lo, hi, *s: torch.randint(lo, hi, s))(0, E, T).to(torch.int64)),
        "dist": _w(dist),
        "angle": _w(angle),
        "centers": _w(centers),
        "ang_freq": _w(ang_freq),
        "w_rbf": _w((lambda *s: torch.randn(*s, dtype=torch.bfloat16) * 0.4)(NR, De)),
        "w_sbf": _w((lambda *s: torch.randn(*s, dtype=torch.bfloat16) * 0.4)(NR * L, De)),
        "w_down": _w((lambda *s: torch.randn(*s, dtype=torch.bfloat16) * 0.4)(De, De)),
        "w_up": _w((lambda *s: torch.randn(*s, dtype=torch.bfloat16) * 0.4)(De, De)),
    }

def reference(m, idx_in, idx_out, dist, angle, centers, ang_freq, w_rbf, w_sbf, w_down, w_up):
    E, De = m.shape[0], m.shape[1]
    NR = centers.shape[0]
    L = ang_freq.shape[0]
    rbf = torch.exp(-10.0 * (dist[:, None] - centers[None, :]) ** 2)
    cbf = torch.cos(ang_freq[None, :] * angle[:, None])
    rbf_t = rbf[idx_out]
    sbf = torch.reshape(rbf_t[:, :, None] * cbf[:, None, :], (-1, NR * L))
    x = (m[idx_in] @ w_down) * (sbf @ w_sbf)
    agg = _segment_sum(x, idx_out, E)
    return m + (agg @ w_up) * (rbf @ w_rbf)
```

```asm
; @launch kernel=k1_kernel grid=(256,1,1) block=(1024,1,1) lds=163840
; @launch kernel=k2_kernel grid=(256,1,1) block=(1024,1,1) lds=156800
.amdgcn_target "amdgcn-amd-amdhsa--gfx950"
.text
.globl k1_kernel
.globl k2_kernel
.p2align 8
.type k1_kernel,@function
k1_kernel:
    s_cmp_ge_u32 s2, 256
    s_cbranch_scc1 k1_end
    s_mov_b32 s3, s2
    s_load_dwordx4 s[4:7], s[0:1], 0
    s_load_dwordx2 s[8:9], s[0:1], 16
    s_load_dwordx2 s[10:11], s[0:1], 32
    s_load_dwordx2 s[12:13], s[0:1], 48
    s_load_dwordx2 s[14:15], s[0:1], 104
    v_lshlrev_b32 v1, 4, v0
    v_lshlrev_b32 v6, 3, v0
    v_add_u32 v4, 0x10000, v1
    v_add_u32 v5, 0x20000, v1
    v_mov_b32 v108, 0
    v_mov_b32 v109, 0
    v_mov_b32 v110, 0
    v_mov_b32 v111, 0
    ds_write_b128 v1, v[108:111]
    v_readfirstlane_b32 s49, v0
    s_waitcnt lgkmcnt(0)
    s_barrier
    s_load_dword s16, s[12:13], 0
    s_lshr_b32 s49, s49, 6
    s_mul_i32 s17, s3, 160000
    s_add_u32 s20, s6, s17
    s_addc_u32 s21, s7, 0
    s_and_b32 s21, s21, 0xffff
    s_mov_b32 s22, 160000
    s_mov_b32 s23, 0x20000
    s_add_u32 s24, s8, s17
    s_addc_u32 s25, s9, 0
    s_and_b32 s25, s25, 0xffff
    s_mov_b32 s26, 160000
    s_mov_b32 s27, 0x20000
    v_cmp_gt_u32 vcc, 1000, v0
    s_and_saveexec_b64 s[60:61], vcc
    s_mov_b64 s[50:51], exec
    s_mov_b32 s48, 0
    buffer_load_dwordx4 v[8:11], v1, s[20:23], s48 offen nt
    buffer_load_dwordx4 v[48:51], v1, s[24:27], s48 offen nt
    s_mov_b64 exec, -1
    s_mul_i32 s17, s3, 80000
    s_add_u32 s28, s10, s17
    s_addc_u32 s29, s11, 0
    s_and_b32 s29, s29, 0xffff
    s_mov_b32 s30, 80000
    s_mov_b32 s31, 0x20000
    s_mul_i32 s17, s3, 10000
    s_add_u32 s32, s4, s17
    s_addc_u32 s33, s5, 0
    s_and_b32 s33, s33, 0xffff
    s_mov_b32 s34, 10000
    s_mov_b32 s35, 0x20000
    buffer_load_dwordx4 v[112:115], v1, s[32:35], 0 offen
    s_lshl_b32 s17, s3, 18
    s_add_u32 s36, s14, s17
    s_addc_u32 s37, s15, 0
    s_and_b32 s37, s37, 0xffff
    s_mov_b32 s38, 262144
    s_mov_b32 s39, 0x20000
    s_lshl_b32 s17, s3, 17
    s_add_u32 s64, s14, s17
    s_addc_u32 s65, s15, 0
    s_add_u32 s64, s64, 67108864
    s_addc_u32 s65, s65, 0
    s_and_b32 s65, s65, 0xffff
    s_mov_b32 s66, 131072
    s_mov_b32 s67, 0x20000
    s_mul_i32 s17, s3, 12288
    s_add_u32 s40, s14, s17
    s_addc_u32 s41, s15, 0
    s_add_u32 s40, s40, 100663296
    s_addc_u32 s41, s41, 0
    s_and_b32 s41, s41, 0xffff
    s_mov_b32 s42, 12288
    s_mov_b32 s43, 0x20000
    s_lshl_b32 s17, s3, 4
    s_add_u32 s44, s14, s17
    s_addc_u32 s45, s15, 0
    s_add_u32 s44, s44, 103809024
    s_addc_u32 s45, s45, 0
    s_and_b32 s45, s45, 0xffff
    s_mov_b32 s46, 16
    s_mov_b32 s47, 0x20000
    s_lshl_b32 s17, s3, 8
    s_add_u32 s68, s14, s17
    s_addc_u32 s69, s15, 0
    s_add_u32 s68, s68, 103813120
    s_addc_u32 s69, s69, 0
    s_and_b32 s69, s69, 0xffff
    s_mov_b32 s70, 4
    s_mov_b32 s71, 0x20000
    s_mov_b32 s52, 639133
    s_mov_b32 s53, 858994
    s_mov_b32 s54, -6720
    s_mov_b32 s55, -5000
    v_mov_b32 v3, 1
    v_mov_b32 v7, 0xffff0000
    s_cmp_ge_u32 s3, 64
    s_cbranch_scc1 k1_nocnt
    s_cmp_lg_u32 s49, 0
    s_cbranch_scc1 k1_nocnt
    v_mov_b32 v108, 0
    v_lshlrev_b32 v109, 2, v0
    buffer_store_dword v108, v109, s[68:71], 0 offen sc1
    s_waitcnt vmcnt(0)
k1_nocnt:
    s_waitcnt lgkmcnt(0)
    s_lshl_b32 s16, s16, 16
    s_cmp_lg_u32 s49, 15
    s_cbranch_scc1 k1_notlb
    s_load_dwordx2 s[78:79], s[0:1], 24
    s_load_dwordx4 s[80:83], s[0:1], 56
    s_load_dwordx4 s[84:87], s[0:1], 72
    s_load_dwordx2 s[88:89], s[0:1], 88
    s_waitcnt lgkmcnt(0)
    s_load_dword s90, s[78:79], 0
    s_load_dword s91, s[80:81], 0
    s_load_dword s92, s[82:83], 0
    s_load_dword s93, s[84:85], 0
    s_load_dword s94, s[86:87], 0
    s_load_dword s95, s[88:89], 0
    s_add_u32 s78, s88, 2097152
    s_addc_u32 s79, s89, 0
    s_load_dword s96, s[78:79], 0
    s_add_u32 s78, s14, 124309760
    s_addc_u32 s79, s15, 0
    s_load_dword s90, s[78:79], 0
    s_add_u32 s78, s14, 126406912
    s_addc_u32 s79, s15, 0
    s_load_dword s91, s[78:79], 0
    s_add_u32 s78, s14, 128504064
    s_addc_u32 s79, s15, 0
    s_load_dword s92, s[78:79], 0
    s_add_u32 s78, s14, 130601216
    s_addc_u32 s79, s15, 0
    s_load_dword s93, s[78:79], 0
    s_add_u32 s78, s14, 132698368
    s_addc_u32 s79, s15, 0
    s_load_dword s94, s[78:79], 0
    s_add_u32 s78, s14, 134795520
    s_addc_u32 s79, s15, 0
    s_load_dword s95, s[78:79], 0
k1_notlb:
    s_cmp_lg_u32 s3, 0
    s_cbranch_scc1 k1_nowp
    s_cmp_lg_u32 s49, 14
    s_cbranch_scc1 k1_nowp
    s_load_dwordx4 s[76:79], s[0:1], 56
    s_load_dwordx4 s[72:75], s[0:1], 72
    s_waitcnt lgkmcnt(0)
    s_load_dwordx16 s[80:95], s[78:79], 0
    s_waitcnt lgkmcnt(0)
    s_pack_ll_b32_b16 s96, s80, s82
    s_pack_hh_b32_b16 s82, s80, s82
    s_mov_b32 s80, s96
    s_pack_ll_b32_b16 s96, s81, s83
    s_pack_hh_b32_b16 s83, s81, s83
    s_mov_b32 s81, s96
    s_pack_ll_b32_b16 s96, s84, s86
    s_pack_hh_b32_b16 s86, s84, s86
    s_mov_b32 s84, s96
    s_pack_ll_b32_b16 s96, s85, s87
    s_pack_hh_b32_b16 s87, s85, s87
    s_mov_b32 s85, s96
    s_pack_ll_b32_b16 s96, s88, s90
    s_pack_hh_b32_b16 s90, s88, s90
    s_mov_b32 s88, s96
    s_pack_ll_b32_b16 s96, s89, s91
    s_pack_hh_b32_b16 s91, s89, s91
    s_mov_b32 s89, s96
    s_pack_ll_b32_b16 s96, s92, s94
    s_pack_hh_b32_b16 s94, s92, s94
    s_mov_b32 s92, s96
    s_pack_ll_b32_b16 s96, s93, s95
    s_pack_hh_b32_b16 s95, s93, s95
    s_mov_b32 s93, s96
    v_writelane_b32 v124, s80, 0
    v_writelane_b32 v124, s81, 1
    v_writelane_b32 v124, s82, 2
    v_writelane_b32 v124, s83, 3
    v_writelane_b32 v124, s84, 4
    v_writelane_b32 v124, s85, 5
    v_writelane_b32 v124, s86, 6
    v_writelane_b32 v124, s87, 7
    v_writelane_b32 v124, s88, 8
    v_writelane_b32 v124, s89, 9
    v_writelane_b32 v124, s90, 10
    v_writelane_b32 v124, s91, 11
    v_writelane_b32 v124, s92, 12
    v_writelane_b32 v124, s93, 13
    v_writelane_b32 v124, s94, 14
    v_writelane_b32 v124, s95, 15
    s_load_dwordx16 s[80:95], s[76:77], 0
    s_waitcnt lgkmcnt(0)
    s_pack_ll_b32_b16 s96, s80, s82
    s_pack_hh_b32_b16 s82, s80, s82
    s_mov_b32 s80, s96
    s_pack_ll_b32_b16 s96, s81, s83
    s_pack_hh_b32_b16 s83, s81, s83
    s_mov_b32 s81, s96
    s_pack_ll_b32_b16 s96, s84, s86
    s_pack_hh_b32_b16 s86, s84, s86
    s_mov_b32 s84, s96
    s_pack_ll_b32_b16 s96, s85, s87
    s_pack_hh_b32_b16 s87, s85, s87
    s_mov_b32 s85, s96
    s_pack_ll_b32_b16 s96, s88, s90
    s_pack_hh_b32_b16 s90, s88, s90
    s_mov_b32 s88, s96
    s_pack_ll_b32_b16 s96, s89, s91
    s_pack_hh_b32_b16 s91, s89, s91
    s_mov_b32 s89, s96
    s_pack_ll_b32_b16 s96, s92, s94
    s_pack_hh_b32_b16 s94, s92, s94
    s_mov_b32 s92, s96
    s_pack_ll_b32_b16 s96, s93, s95
    s_pack_hh_b32_b16 s95, s93, s95
    s_mov_b32 s93, s96
    v_writelane_b32 v124, s80, 16
    v_writelane_b32 v124, s81, 17
    v_writelane_b32 v124, s82, 18
    v_writelane_b32 v124, s83, 19
    v_writelane_b32 v124, s84, 20
    v_writelane_b32 v124, s85, 21
    v_writelane_b32 v124, s86, 22
    v_writelane_b32 v124, s87, 23
    v_writelane_b32 v124, s88, 24
    v_writelane_b32 v124, s89, 25
    v_writelane_b32 v124, s90, 26
    v_writelane_b32 v124, s91, 27
    v_writelane_b32 v124, s92, 28
    v_writelane_b32 v124, s93, 29
    v_writelane_b32 v124, s94, 30
    v_writelane_b32 v124, s95, 31
    s_load_dwordx8 s[80:87], s[72:73], 0
    s_load_dwordx8 s[88:95], s[74:75], 0
    s_waitcnt lgkmcnt(0)
    s_lshl_b32 s96, s80, 16
    v_writelane_b32 v124, s96, 32
    s_and_b32 s96, s80, 0xffff0000
    v_writelane_b32 v124, s96, 33
    s_lshl_b32 s96, s81, 16
    v_writelane_b32 v124, s96, 34
    s_and_b32 s96, s81, 0xffff0000
    v_writelane_b32 v124, s96, 35
    s_lshl_b32 s96, s82, 16
    v_writelane_b32 v124, s96, 36
    s_and_b32 s96, s82, 0xffff0000
    v_writelane_b32 v124, s96, 37
    s_lshl_b32 s96, s83, 16
    v_writelane_b32 v124, s96, 38
    s_and_b32 s96, s83, 0xffff0000
    v_writelane_b32 v124, s96, 39
    s_lshl_b32 s96, s84, 16
    v_writelane_b32 v124, s96, 40
    s_and_b32 s96, s84, 0xffff0000
    v_writelane_b32 v124, s96, 41
    s_lshl_b32 s96, s85, 16
    v_writelane_b32 v124, s96, 42
    s_and_b32 s96, s85, 0xffff0000
    v_writelane_b32 v124, s96, 43
    s_lshl_b32 s96, s86, 16
    v_writelane_b32 v124, s96, 44
    s_and_b32 s96, s86, 0xffff0000
    v_writelane_b32 v124, s96, 45
    s_lshl_b32 s96, s87, 16
    v_writelane_b32 v124, s96, 46
    s_and_b32 s96, s87, 0xffff0000
    v_writelane_b32 v124, s96, 47
    s_pack_ll_b32_b16 s96, s88, s90
    s_pack_hh_b32_b16 s90, s88, s90
    s_mov_b32 s88, s96
    s_pack_ll_b32_b16 s96, s89, s91
    s_pack_hh_b32_b16 s91, s89, s91
    s_mov_b32 s89, s96
    s_pack_ll_b32_b16 s96, s92, s94
    s_pack_hh_b32_b16 s94, s92, s94
    s_mov_b32 s92, s96
    s_pack_ll_b32_b16 s96, s93, s95
    s_pack_hh_b32_b16 s95, s93, s95
    s_mov_b32 s93, s96
    v_writelane_b32 v124, s88, 48
    v_writelane_b32 v124, s89, 49
    v_writelane_b32 v124, s90, 50
    v_writelane_b32 v124, s91, 51
    v_writelane_b32 v124, s92, 52
    v_writelane_b32 v124, s93, 53
    v_writelane_b32 v124, s94, 54
    v_writelane_b32 v124, s95, 55
    s_add_u32 s76, s14, 103829504
    s_addc_u32 s77, s15, 0
    s_and_b32 s77, s77, 0xffff
    s_mov_b32 s78, 224
    s_mov_b32 s79, 0x20000
    v_and_b32 v125, 63, v0
    v_lshlrev_b32 v125, 2, v125
    buffer_store_dword v124, v125, s[76:79], 0 offen sc1
    s_waitcnt vmcnt(0)
k1_nowp:
    s_lshr_b32 s17, s2, 3
    s_and_b32 s17, s17, 0
    s_mov_b64 exec, s[50:51]
    s_mov_b32 s48, 16000
    buffer_load_dwordx4 v[12:15], v1, s[20:23], s48 offen nt
    buffer_load_dwordx4 v[52:55], v1, s[24:27], s48 offen nt
    s_mov_b32 s48, 32000
    buffer_load_dwordx4 v[16:19], v1, s[20:23], s48 offen nt
    buffer_load_dwordx4 v[56:59], v1, s[24:27], s48 offen nt
    s_mov_b32 s48, 48000
    buffer_load_dwordx4 v[20:23], v1, s[20:23], s48 offen nt
    buffer_load_dwordx4 v[60:63], v1, s[24:27], s48 offen nt
    s_mov_b32 s48, 64000
    buffer_load_dwordx4 v[24:27], v1, s[20:23], s48 offen nt
    buffer_load_dwordx4 v[64:67], v1, s[24:27], s48 offen nt
    s_mov_b32 s48, 80000
    buffer_load_dwordx4 v[28:31], v1, s[20:23], s48 offen nt
    buffer_load_dwordx4 v[68:71], v1, s[24:27], s48 offen nt
    s_mov_b32 s48, 96000
    buffer_load_dwordx4 v[32:35], v1, s[20:23], s48 offen nt
    buffer_load_dwordx4 v[72:75], v1, s[24:27], s48 offen nt
    s_mov_b32 s48, 112000
    buffer_load_dwordx4 v[36:39], v1, s[20:23], s48 offen nt
    buffer_load_dwordx4 v[76:79], v1, s[24:27], s48 offen nt
    s_waitcnt vmcnt(15)
    s_mov_b32 s48, 128000
    buffer_load_dwordx4 v[40:43], v1, s[20:23], s48 offen nt
    buffer_load_dwordx4 v[80:83], v1, s[24:27], s48 offen nt
    v_mul_hi_u32_u24 v116, s52, v8
    v_mul_hi_u32_u24 v117, s53, v48
    v_mad_i32_i24 v8, v116, s54, v8
    v_mad_i32_i24 v48, v117, s55, v48
    v_lshlrev_b32 v117, 2, v117
    v_lshl_or_b32 v8, v48, 16, v8
    v_lshl_add_u32 v48, v116, 8, v117
    ds_add_u32 v48, v3 offset:512
    v_lshlrev_b32 v8, 3, v8
    v_mul_hi_u32_u24 v118, s52, v9
    v_mul_hi_u32_u24 v119, s53, v49
    v_mad_i32_i24 v9, v118, s54, v9
    v_mad_i32_i24 v49, v119, s55, v49
    v_lshlrev_b32 v119, 2, v119
    v_lshl_or_b32 v9, v49, 16, v9
    v_lshl_add_u32 v49, v118, 8, v119
    ds_add_u32 v49, v3 offset:512
    v_lshlrev_b32 v9, 3, v9
    v_mul_hi_u32_u24 v120, s52, v10
    v_mul_hi_u32_u24 v121, s53, v50
    v_mad_i32_i24 v10, v120, s54, v10
    v_mad_i32_i24 v50, v121, s55, v50
    v_lshlrev_b32 v121, 2, v121
    v_lshl_or_b32 v10, v50, 16, v10
    v_lshl_add_u32 v50, v120, 8, v121
    ds_add_u32 v50, v3 offset:512
    v_lshlrev_b32 v10, 3, v10
    v_mul_hi_u32_u24 v122, s52, v11
    v_mul_hi_u32_u24 v123, s53, v51
    v_mad_i32_i24 v11, v122, s54, v11
    v_mad_i32_i24 v51, v123, s55, v51
    v_lshlrev_b32 v123, 2, v123
    v_lshl_or_b32 v11, v51, 16, v11
    v_lshl_add_u32 v51, v122, 8, v123
    ds_add_u32 v51, v3 offset:512
    v_lshlrev_b32 v11, 3, v11
    s_waitcnt vmcnt(14)
    s_mov_b32 s48, 144000
    buffer_load_dwordx4 v[44:47], v1, s[20:23], s48 offen nt
    buffer_load_dwordx4 v[84:87], v1, s[24:27], s48 offen nt
    v_mul_hi_u32_u24 v116, s52, v12
    v_mul_hi_u32_u24 v117, s53, v52
    v_mad_i32_i24 v12, v116, s54, v12
    v_mad_i32_i24 v52, v117, s55, v52
    v_lshlrev_b32 v117, 2, v117
    v_lshl_or_b32 v12, v52, 16, v12
    v_lshl_add_u32 v52, v116, 8, v117
    ds_add_u32 v52, v3 offset:512
    v_lshlrev_b32 v12, 3, v12
    v_mul_hi_u32_u24 v118, s52, v13
    v_mul_hi_u32_u24 v119, s53, v53
    v_mad_i32_i24 v13, v118, s54, v13
    v_mad_i32_i24 v53, v119, s55, v53
    v_lshlrev_b32 v119, 2, v119
    v_lshl_or_b32 v13, v53, 16, v13
    v_lshl_add_u32 v53, v118, 8, v119
    ds_add_u32 v53, v3 offset:512
    v_lshlrev_b32 v13, 3, v13
    v_mul_hi_u32_u24 v120, s52, v14
    v_mul_hi_u32_u24 v121, s53, v54
    v_mad_i32_i24 v14, v120, s54, v14
    v_mad_i32_i24 v54, v121, s55, v54
    v_lshlrev_b32 v121, 2, v121
    v_lshl_or_b32 v14, v54, 16, v14
    v_lshl_add_u32 v54, v120, 8, v121
    ds_add_u32 v54, v3 offset:512
    v_lshlrev_b32 v14, 3, v14
    v_mul_hi_u32_u24 v122, s52, v15
    v_mul_hi_u32_u24 v123, s53, v55
    v_mad_i32_i24 v15, v122, s54, v15
    v_mad_i32_i24 v55, v123, s55, v55
    v_lshlrev_b32 v123, 2, v123
    v_lshl_or_b32 v15, v55, 16, v15
    v_lshl_add_u32 v55, v122, 8, v123
    ds_add_u32 v55, v3 offset:512
    v_lshlrev_b32 v15, 3, v15
    s_mov_b64 exec, -1
    s_cmp_ge_u32 s49, 10
    s_cbranch_scc1 k1_nomax_1
    s_mov_b32 s17, 0x7fff7fff
    v_and_b32 v112, s17, v112
    v_and_b32 v113, s17, v113
    v_and_b32 v114, s17, v114
    v_and_b32 v115, s17, v115
    v_pk_max_u16 v112, v112, v114
    v_pk_max_u16 v113, v113, v115
    v_and_b32 v108, 0xffff, v112
    v_lshrrev_b32 v109, 16, v112
    v_and_b32 v110, 0xffff, v113
    v_lshrrev_b32 v111, 16, v113
    s_nop 1
    v_max_u32_dpp v108, v108, v108 row_shr:1 row_mask:0xf bank_mask:0xf
    v_max_u32_dpp v109, v109, v109 row_shr:1 row_mask:0xf bank_mask:0xf
    v_max_u32_dpp v110, v110, v110 row_shr:1 row_mask:0xf bank_mask:0xf
    v_max_u32_dpp v111, v111, v111 row_shr:1 row_mask:0xf bank_mask:0xf
    s_nop 1
    v_max_u32_dpp v108, v108, v108 row_shr:2 row_mask:0xf bank_mask:0xf
    v_max_u32_dpp v109, v109, v109 row_shr:2 row_mask:0xf bank_mask:0xf
    v_max_u32_dpp v110, v110, v110 row_shr:2 row_mask:0xf bank_mask:0xf
    v_max_u32_dpp v111, v111, v111 row_shr:2 row_mask:0xf bank_mask:0xf
    s_nop 1
    v_max_u32_dpp v108, v108, v108 row_shr:4 row_mask:0xf bank_mask:0xf
    v_max_u32_dpp v109, v109, v109 row_shr:4 row_mask:0xf bank_mask:0xf
    v_max_u32_dpp v110, v110, v110 row_shr:4 row_mask:0xf bank_mask:0xf
    v_max_u32_dpp v111, v111, v111 row_shr:4 row_mask:0xf bank_mask:0xf
    s_nop 1
    v_max_u32_dpp v108, v108, v108 row_shr:8 row_mask:0xf bank_mask:0xf
    v_max_u32_dpp v109, v109, v109 row_shr:8 row_mask:0xf bank_mask:0xf
    v_max_u32_dpp v110, v110, v110 row_shr:8 row_mask:0xf bank_mask:0xf
    v_max_u32_dpp v111, v111, v111 row_shr:8 row_mask:0xf bank_mask:0xf
    v_mov_b32 v112, 128
    s_mov_b32 exec_lo, 0x80008000
    s_mov_b32 exec_hi, 0x80008000
    ds_max_u32 v112, v108 offset:0
    ds_max_u32 v112, v109 offset:4
    ds_max_u32 v112, v110 offset:8
    ds_max_u32 v112, v111 offset:12
k1_nomax_1:
    s_mov_b64 exec, s[50:51]
    s_waitcnt vmcnt(14)
    v_mul_hi_u32_u24 v116, s52, v16
    v_mul_hi_u32_u24 v117, s53, v56
    v_mad_i32_i24 v16, v116, s54, v16
    v_mad_i32_i24 v56, v117, s55, v56
    v_lshlrev_b32 v117, 2, v117
    v_lshl_or_b32 v16, v56, 16, v16
    v_lshl_add_u32 v56, v116, 8, v117
    ds_add_u32 v56, v3 offset:512
    v_lshlrev_b32 v16, 3, v16
    v_mul_hi_u32_u24 v118, s52, v17
    v_mul_hi_u32_u24 v119, s53, v57
    v_mad_i32_i24 v17, v118, s54, v17
    v_mad_i32_i24 v57, v119, s55, v57
    v_lshlrev_b32 v119, 2, v119
    v_lshl_or_b32 v17, v57, 16, v17
    v_lshl_add_u32 v57, v118, 8, v119
    ds_add_u32 v57, v3 offset:512
    v_lshlrev_b32 v17, 3, v17
    v_mul_hi_u32_u24 v120, s52, v18
    v_mul_hi_u32_u24 v121, s53, v58
    v_mad_i32_i24 v18, v120, s54, v18
    v_mad_i32_i24 v58, v121, s55, v58
    v_lshlrev_b32 v121, 2, v121
    v_lshl_or_b32 v18, v58, 16, v18
    v_lshl_add_u32 v58, v120, 8, v121
    ds_add_u32 v58, v3 offset:512
    v_lshlrev_b32 v18, 3, v18
    v_mul_hi_u32_u24 v122, s52, v19
    v_mul_hi_u32_u24 v123, s53, v59
    v_mad_i32_i24 v19, v122, s54, v19
    v_mad_i32_i24 v59, v123, s55, v59
    v_lshlrev_b32 v123, 2, v123
    v_lshl_or_b32 v19, v59, 16, v19
    v_lshl_add_u32 v59, v122, 8, v123
    ds_add_u32 v59, v3 offset:512
    v_lshlrev_b32 v19, 3, v19
    s_waitcnt vmcnt(12)
    v_mul_hi_u32_u24 v116, s52, v20
    v_mul_hi_u32_u24 v117, s53, v60
    v_mad_i32_i24 v20, v116, s54, v20
    v_mad_i32_i24 v60, v117, s55, v60
    v_lshlrev_b32 v117, 2, v117
    v_lshl_or_b32 v20, v60, 16, v20
    v_lshl_add_u32 v60, v116, 8, v117
    ds_add_u32 v60, v3 offset:512
    v_lshlrev_b32 v20, 3, v20
    v_mul_hi_u32_u24 v118, s52, v21
    v_mul_hi_u32_u24 v119, s53, v61
    v_mad_i32_i24 v21, v118, s54, v21
    v_mad_i32_i24 v61, v119, s55, v61
    v_lshlrev_b32 v119, 2, v119
    v_lshl_or_b32 v21, v61, 16, v21
    v_lshl_add_u32 v61, v118, 8, v119
    ds_add_u32 v61, v3 offset:512
    v_lshlrev_b32 v21, 3, v21
    v_mul_hi_u32_u24 v120, s52, v22
    v_mul_hi_u32_u24 v121, s53, v62
    v_mad_i32_i24 v22, v120, s54, v22
    v_mad_i32_i24 v62, v121, s55, v62
    v_lshlrev_b32 v121, 2, v121
    v_lshl_or_b32 v22, v62, 16, v22
    v_lshl_add_u32 v62, v120, 8, v121
    ds_add_u32 v62, v3 offset:512
    v_lshlrev_b32 v22, 3, v22
    v_mul_hi_u32_u24 v122, s52, v23
    v_mul_hi_u32_u24 v123, s53, v63
    v_mad_i32_i24 v23, v122, s54, v23
    v_mad_i32_i24 v63, v123, s55, v63
    v_lshlrev_b32 v123, 2, v123
    v_lshl_or_b32 v23, v63, 16, v23
    v_lshl_add_u32 v63, v122, 8, v123
    ds_add_u32 v63, v3 offset:512
    v_lshlrev_b32 v23, 3, v23
    s_waitcnt vmcnt(10)
    v_mul_hi_u32_u24 v116, s52, v24
    v_mul_hi_u32_u24 v117, s53, v64
    v_mad_i32_i24 v24, v116, s54, v24
    v_mad_i32_i24 v64, v117, s55, v64
    v_lshlrev_b32 v117, 2, v117
    v_lshl_or_b32 v24, v64, 16, v24
    v_lshl_add_u32 v64, v116, 8, v117
    ds_add_u32 v64, v3 offset:512
    v_lshlrev_b32 v24, 3, v24
    v_mul_hi_u32_u24 v118, s52, v25
    v_mul_hi_u32_u24 v119, s53, v65
    v_mad_i32_i24 v25, v118, s54, v25
    v_mad_i32_i24 v65, v119, s55, v65
    v_lshlrev_b32 v119, 2, v119
    v_lshl_or_b32 v25, v65, 16, v25
    v_lshl_add_u32 v65, v118, 8, v119
    ds_add_u32 v65, v3 offset:512
    v_lshlrev_b32 v25, 3, v25
    v_mul_hi_u32_u24 v120, s52, v26
    v_mul_hi_u32_u24 v121, s53, v66
    v_mad_i32_i24 v26, v120, s54, v26
    v_mad_i32_i24 v66, v121, s55, v66
    v_lshlrev_b32 v121, 2, v121
    v_lshl_or_b32 v26, v66, 16, v26
    v_lshl_add_u32 v66, v120, 8, v121
    ds_add_u32 v66, v3 offset:512
    v_lshlrev_b32 v26, 3, v26
    v_mul_hi_u32_u24 v122, s52, v27
    v_mul_hi_u32_u24 v123, s53, v67
    v_mad_i32_i24 v27, v122, s54, v27
    v_mad_i32_i24 v67, v123, s55, v67
    v_lshlrev_b32 v123, 2, v123
    v_lshl_or_b32 v27, v67, 16, v27
    v_lshl_add_u32 v67, v122, 8, v123
    ds_add_u32 v67, v3 offset:512
    v_lshlrev_b32 v27, 3, v27
    s_waitcnt vmcnt(8)
    v_mul_hi_u32_u24 v116, s52, v28
    v_mul_hi_u32_u24 v117, s53, v68
    v_mad_i32_i24 v28, v116, s54, v28
    v_mad_i32_i24 v68, v117, s55, v68
    v_lshlrev_b32 v117, 2, v117
    v_lshl_or_b32 v28, v68, 16, v28
    v_lshl_add_u32 v68, v116, 8, v117
    ds_add_u32 v68, v3 offset:512
    v_lshlrev_b32 v28, 3, v28
    v_mul_hi_u32_u24 v118, s52, v29
    v_mul_hi_u32_u24 v119, s53, v69
    v_mad_i32_i24 v29, v118, s54, v29
    v_mad_i32_i24 v69, v119, s55, v69
    v_lshlrev_b32 v119, 2, v119
    v_lshl_or_b32 v29, v69, 16, v29
    v_lshl_add_u32 v69, v118, 8, v119
    ds_add_u32 v69, v3 offset:512
    v_lshlrev_b32 v29, 3, v29
    v_mul_hi_u32_u24 v120, s52, v30
    v_mul_hi_u32_u24 v121, s53, v70
    v_mad_i32_i24 v30, v120, s54, v30
    v_mad_i32_i24 v70, v121, s55, v70
    v_lshlrev_b32 v121, 2, v121
    v_lshl_or_b32 v30, v70, 16, v30
    v_lshl_add_u32 v70, v120, 8, v121
    ds_add_u32 v70, v3 offset:512
    v_lshlrev_b32 v30, 3, v30
    v_mul_hi_u32_u24 v122, s52, v31
    v_mul_hi_u32_u24 v123, s53, v71
    v_mad_i32_i24 v31, v122, s54, v31
    v_mad_i32_i24 v71, v123, s55, v71
    v_lshlrev_b32 v123, 2, v123
    v_lshl_or_b32 v31, v71, 16, v31
    v_lshl_add_u32 v71, v122, 8, v123
    ds_add_u32 v71, v3 offset:512
    v_lshlrev_b32 v31, 3, v31
    s_waitcnt vmcnt(6)
    v_mul_hi_u32_u24 v116, s52, v32
    v_mul_hi_u32_u24 v117, s53, v72
    v_mad_i32_i24 v32, v116, s54, v32
    v_mad_i32_i24 v72, v117, s55, v72
    v_lshlrev_b32 v117, 2, v117
    v_lshl_or_b32 v32, v72, 16, v32
    v_lshl_add_u32 v72, v116, 8, v117
    ds_add_u32 v72, v3 offset:512
    v_lshlrev_b32 v32, 3, v32
    v_mul_hi_u32_u24 v118, s52, v33
    v_mul_hi_u32_u24 v119, s53, v73
    v_mad_i32_i24 v33, v118, s54, v33
    v_mad_i32_i24 v73, v119, s55, v73
    v_lshlrev_b32 v119, 2, v119
    v_lshl_or_b32 v33, v73, 16, v33
    v_lshl_add_u32 v73, v118, 8, v119
    ds_add_u32 v73, v3 offset:512
    v_lshlrev_b32 v33, 3, v33
    v_mul_hi_u32_u24 v120, s52, v34
    v_mul_hi_u32_u24 v121, s53, v74
    v_mad_i32_i24 v34, v120, s54, v34
    v_mad_i32_i24 v74, v121, s55, v74
    v_lshlrev_b32 v121, 2, v121
    v_lshl_or_b32 v34, v74, 16, v34
    v_lshl_add_u32 v74, v120, 8, v121
    ds_add_u32 v74, v3 offset:512
    v_lshlrev_b32 v34, 3, v34
    v_mul_hi_u32_u24 v122, s52, v35
    v_mul_hi_u32_u24 v123, s53, v75
    v_mad_i32_i24 v35, v122, s54, v35
    v_mad_i32_i24 v75, v123, s55, v75
    v_lshlrev_b32 v123, 2, v123
    v_lshl_or_b32 v35, v75, 16, v35
    v_lshl_add_u32 v75, v122, 8, v123
    ds_add_u32 v75, v3 offset:512
    v_lshlrev_b32 v35, 3, v35
    s_waitcnt vmcnt(4)
    v_mul_hi_u32_u24 v116, s52, v36
    v_mul_hi_u32_u24 v117, s53, v76
    v_mad_i32_i24 v36, v116, s54, v36
    v_mad_i32_i24 v76, v117, s55, v76
    v_lshlrev_b32 v117, 2, v117
    v_lshl_or_b32 v36, v76, 16, v36
    v_lshl_add_u32 v76, v116, 8, v117
    ds_add_u32 v76, v3 offset:512
    v_lshlrev_b32 v36, 3, v36
    v_mul_hi_u32_u24 v118, s52, v37
    v_mul_hi_u32_u24 v119, s53, v77
    v_mad_i32_i24 v37, v118, s54, v37
    v_mad_i32_i24 v77, v119, s55, v77
    v_lshlrev_b32 v119, 2, v119
    v_lshl_or_b32 v37, v77, 16, v37
    v_lshl_add_u32 v77, v118, 8, v119
    ds_add_u32 v77, v3 offset:512
    v_lshlrev_b32 v37, 3, v37
    v_mul_hi_u32_u24 v120, s52, v38
    v_mul_hi_u32_u24 v121, s53, v78
    v_mad_i32_i24 v38, v120, s54, v38
    v_mad_i32_i24 v78, v121, s55, v78
    v_lshlrev_b32 v121, 2, v121
    v_lshl_or_b32 v38, v78, 16, v38
    v_lshl_add_u32 v78, v120, 8, v121
    ds_add_u32 v78, v3 offset:512
    v_lshlrev_b32 v38, 3, v38
    v_mul_hi_u32_u24 v122, s52, v39
    v_mul_hi_u32_u24 v123, s53, v79
    v_mad_i32_i24 v39, v122, s54, v39
    v_mad_i32_i24 v79, v123, s55, v79
    v_lshlrev_b32 v123, 2, v123
    v_lshl_or_b32 v39, v79, 16, v39
    v_lshl_add_u32 v79, v122, 8, v123
    ds_add_u32 v79, v3 offset:512
    v_lshlrev_b32 v39, 3, v39
    s_waitcnt vmcnt(2)
    v_mul_hi_u32_u24 v116, s52, v40
    v_mul_hi_u32_u24 v117, s53, v80
    v_mad_i32_i24 v40, v116, s54, v40
    v_mad_i32_i24 v80, v117, s55, v80
    v_lshlrev_b32 v117, 2, v117
    v_lshl_or_b32 v40, v80, 16, v40
    v_lshl_add_u32 v80, v116, 8, v117
    ds_add_u32 v80, v3 offset:512
    v_lshlrev_b32 v40, 3, v40
    v_mul_hi_u32_u24 v118, s52, v41
    v_mul_hi_u32_u24 v119, s53, v81
    v_mad_i32_i24 v41, v118, s54, v41
    v_mad_i32_i24 v81, v119, s55, v81
    v_lshlrev_b32 v119, 2, v119
    v_lshl_or_b32 v41, v81, 16, v41
    v_lshl_add_u32 v81, v118, 8, v119
    ds_add_u32 v81, v3 offset:512
    v_lshlrev_b32 v41, 3, v41
    v_mul_hi_u32_u24 v120, s52, v42
    v_mul_hi_u32_u24 v121, s53, v82
    v_mad_i32_i24 v42, v120, s54, v42
    v_mad_i32_i24 v82, v121, s55, v82
    v_lshlrev_b32 v121, 2, v121
    v_lshl_or_b32 v42, v82, 16, v42
    v_lshl_add_u32 v82, v120, 8, v121
    ds_add_u32 v82, v3 offset:512
    v_lshlrev_b32 v42, 3, v42
    v_mul_hi_u32_u24 v122, s52, v43
    v_mul_hi_u32_u24 v123, s53, v83
    v_mad_i32_i24 v43, v122, s54, v43
    v_mad_i32_i24 v83, v123, s55, v83
    v_lshlrev_b32 v123, 2, v123
    v_lshl_or_b32 v43, v83, 16, v43
    v_lshl_add_u32 v83, v122, 8, v123
    ds_add_u32 v83, v3 offset:512
    v_lshlrev_b32 v43, 3, v43
    s_waitcnt vmcnt(0)
    v_mul_hi_u32_u24 v116, s52, v44
    v_mul_hi_u32_u24 v117, s53, v84
    v_mad_i32_i24 v44, v116, s54, v44
    v_mad_i32_i24 v84, v117, s55, v84
    v_lshlrev_b32 v117, 2, v117
    v_lshl_or_b32 v44, v84, 16, v44
    v_lshl_add_u32 v84, v116, 8, v117
    ds_add_u32 v84, v3 offset:512
    v_lshlrev_b32 v44, 3, v44
    v_mul_hi_u32_u24 v118, s52, v45
    v_mul_hi_u32_u24 v119, s53, v85
    v_mad_i32_i24 v45, v118, s54, v45
    v_mad_i32_i24 v85, v119, s55, v85
    v_lshlrev_b32 v119, 2, v119
    v_lshl_or_b32 v45, v85, 16, v45
    v_lshl_add_u32 v85, v118, 8, v119
    ds_add_u32 v85, v3 offset:512
    v_lshlrev_b32 v45, 3, v45
    v_mul_hi_u32_u24 v120, s52, v46
    v_mul_hi_u32_u24 v121, s53, v86
    v_mad_i32_i24 v46, v120, s54, v46
    v_mad_i32_i24 v86, v121, s55, v86
    v_lshlrev_b32 v121, 2, v121
    v_lshl_or_b32 v46, v86, 16, v46
    v_lshl_add_u32 v86, v120, 8, v121
    ds_add_u32 v86, v3 offset:512
    v_lshlrev_b32 v46, 3, v46
    v_mul_hi_u32_u24 v122, s52, v47
    v_mul_hi_u32_u24 v123, s53, v87
    v_mad_i32_i24 v47, v122, s54, v47
    v_mad_i32_i24 v87, v123, s55, v87
    v_lshlrev_b32 v123, 2, v123
    v_lshl_or_b32 v47, v87, 16, v47
    v_lshl_add_u32 v87, v122, 8, v123
    ds_add_u32 v87, v3 offset:512
    v_lshlrev_b32 v47, 3, v47
k1_p1done:
    s_mov_b64 exec, -1
    s_waitcnt lgkmcnt(0)
    s_barrier
    s_cmp_ge_u32 s49, 12
    s_cbranch_scc1 k1_scan1_skip
    ds_read_b128 v[108:111], v1 offset:512
    s_waitcnt lgkmcnt(0)
    v_mov_b32 v112, v108
    v_mov_b32 v113, v109
    v_mov_b32 v114, v110
    v_mov_b32 v115, v111
    v_add_u32 v116, v112, v113
    v_add_u32 v117, v116, v114
    v_add_u32 v118, v117, v115
    v_mov_b32 v119, v118
    s_nop 1
    v_add_u32_dpp v119, v119, v119 row_shr:1 row_mask:0xf bank_mask:0xf
    s_nop 1
    v_add_u32_dpp v119, v119, v119 row_shr:2 row_mask:0xf bank_mask:0xf
    s_nop 1
    v_add_u32_dpp v119, v119, v119 row_shr:4 row_mask:0xf bank_mask:0xf
    s_nop 1
    v_add_u32_dpp v119, v119, v119 row_shr:8 row_mask:0xf bank_mask:0xf
    s_nop 1
    v_add_u32_dpp v119, v119, v119 row_bcast:15 row_mask:0xa bank_mask:0xf
    s_nop 1
    v_add_u32_dpp v119, v119, v119 row_bcast:31 row_mask:0xc bank_mask:0xf
    s_nop 1
    s_nop 1
    s_lshl_b32 s17, s49, 2
    s_add_u32 s17, s17, 0
    v_mov_b32 v120, s17
    s_mov_b32 exec_lo, 0
    s_mov_b32 exec_hi, 0x80000000
    ds_write_b32 v120, v119
    s_mov_b64 exec, -1
    s_waitcnt lgkmcnt(0)
k1_scan1_skip:
    s_barrier
    v_and_b32 v120, 15, v0
    v_lshlrev_b32 v120, 2, v120
    ds_read_b32 v121, v120 offset:0
    s_waitcnt lgkmcnt(0)
    v_mov_b32 v122, v121
    s_nop 1
    v_add_u32_dpp v122, v122, v122 row_shr:1 row_mask:0xf bank_mask:0xf
    s_nop 1
    v_add_u32_dpp v122, v122, v122 row_shr:2 row_mask:0xf bank_mask:0xf
    s_nop 1
    v_add_u32_dpp v122, v122, v122 row_shr:4 row_mask:0xf bank_mask:0xf
    s_nop 1
    v_add_u32_dpp v122, v122, v122 row_shr:8 row_mask:0xf bank_mask:0xf
    s_nop 1
    s_nop 1
    v_sub_u32 v121, v122, v121
    s_nop 1
    v_readlane_b32 s58, v122, 15
    v_readlane_b32 s59, v121, s49
    s_cmp_ge_u32 s49, 12
    s_cbranch_scc1 k1_scan2_done
    v_sub_u32 v119, v119, v118
    v_add_u32 v119, s59, v119
    v_add_u32 v117, v119, v117
    v_add_u32 v116, v119, v116
    v_add_u32 v113, v119, v112
    v_mov_b32 v112, v119
    v_mov_b32 v114, v116
    v_mov_b32 v115, v117
    ds_write_b128 v1, v[112:115] offset:512
    v_lshl_or_b32 v124, v108, 16, v112
    v_lshl_or_b32 v125, v109, 16, v113
    v_lshl_or_b32 v126, v110, 16, v114
    v_lshl_or_b32 v127, v111, 16, v115
k1_scan2_done:
    s_waitcnt lgkmcnt(0)
    s_barrier
    s_mov_b64 exec, s[50:51]
    ds_add_rtn_u32 v48, v48, v3 offset:512
    ds_add_rtn_u32 v49, v49, v3 offset:512
    ds_add_rtn_u32 v50, v50, v3 offset:512
    ds_add_rtn_u32 v51, v51, v3 offset:512
    s_mov_b32 s48, 0
    buffer_load_dwordx2 v[88:89], v6, s[28:31], s48 offen nt
    ds_add_rtn_u32 v52, v52, v3 offset:512
    ds_add_rtn_u32 v53, v53, v3 offset:512
    ds_add_rtn_u32 v54, v54, v3 offset:512
    ds_add_rtn_u32 v55, v55, v3 offset:512
    s_mov_b32 s48, 8000
    buffer_load_dwordx2 v[90:91], v6, s[28:31], s48 offen nt
    ds_add_rtn_u32 v56, v56, v3 offset:512
    ds_add_rtn_u32 v57, v57, v3 offset:512
    ds_add_rtn_u32 v58, v58, v3 offset:512
    ds_add_rtn_u32 v59, v59, v3 offset:512
    s_mov_b32 s48, 16000
    buffer_load_dwordx2 v[92:93], v6, s[28:31], s48 offen nt
    ds_add_rtn_u32 v60, v60, v3 offset:512
    ds_add_rtn_u32 v61, v61, v3 offset:512
    ds_add_rtn_u32 v62, v62, v3 offset:512
    ds_add_rtn_u32 v63, v63, v3 offset:512
    s_mov_b32 s48, 24000
    buffer_load_dwordx2 v[94:95], v6, s[28:31], s48 offen nt
    ds_add_rtn_u32 v64, v64, v3 offset:512
    ds_add_rtn_u32 v65, v65, v3 offset:512
    ds_add_rtn_u32 v66, v66, v3 offset:512
    ds_add_rtn_u32 v67, v67, v3 offset:512
    s_mov_b32 s48, 32000
    buffer_load_dwordx2 v[96:97], v6, s[28:31], s48 offen nt
    ds_add_rtn_u32 v68, v68, v3 offset:512
    ds_add_rtn_u32 v69, v69, v3 offset:512
    ds_add_rtn_u32 v70, v70, v3 offset:512
    ds_add_rtn_u32 v71, v71, v3 offset:512
    s_mov_b32 s48, 40000
    buffer_load_dwordx2 v[98:99], v6, s[28:31], s48 offen nt
    ds_add_rtn_u32 v72, v72, v3 offset:512
    ds_add_rtn_u32 v73, v73, v3 offset:512
    ds_add_rtn_u32 v74, v74, v3 offset:512
    ds_add_rtn_u32 v75, v75, v3 offset:512
    s_mov_b32 s48, 48000
    buffer_load_dwordx2 v[100:101], v6, s[28:31], s48 offen nt
    ds_add_rtn_u32 v76, v76, v3 offset:512
    ds_add_rtn_u32 v77, v77, v3 offset:512
    ds_add_rtn_u32 v78, v78, v3 offset:512
    ds_add_rtn_u32 v79, v79, v3 offset:512
    s_mov_b32 s48, 56000
    buffer_load_dwordx2 v[102:103], v6, s[28:31], s48 offen nt
    ds_add_rtn_u32 v80, v80, v3 offset:512
    ds_add_rtn_u32 v81, v81, v3 offset:512
    ds_add_rtn_u32 v82, v82, v3 offset:512
    ds_add_rtn_u32 v83, v83, v3 offset:512
    s_mov_b32 s48, 64000
    buffer_load_dwordx2 v[104:105], v6, s[28:31], s48 offen nt
    ds_add_rtn_u32 v84, v84, v3 offset:512
    ds_add_rtn_u32 v85, v85, v3 offset:512
    ds_add_rtn_u32 v86, v86, v3 offset:512
    ds_add_rtn_u32 v87, v87, v3 offset:512
    s_mov_b32 s48, 72000
    buffer_load_dwordx2 v[106:107], v6, s[28:31], s48 offen nt
    s_waitcnt lgkmcnt(0)
    s_barrier
    v_lshlrev_b32 v116, 2, v48
    ds_write_b32 v116, v8 offset:512
    v_lshlrev_b32 v117, 2, v49
    ds_write_b32 v117, v9 offset:512
    v_lshlrev_b32 v118, 2, v50
    ds_write_b32 v118, v10 offset:512
    v_lshlrev_b32 v119, 2, v51
    ds_write_b32 v119, v11 offset:512
    v_lshlrev_b32 v120, 2, v52
    ds_write_b32 v120, v12 offset:512
    v_lshlrev_b32 v121, 2, v53
    ds_write_b32 v121, v13 offset:512
    v_lshlrev_b32 v122, 2, v54
    ds_write_b32 v122, v14 offset:512
    v_lshlrev_b32 v123, 2, v55
    ds_write_b32 v123, v15 offset:512
    v_lshlrev_b32 v116, 2, v56
    ds_write_b32 v116, v16 offset:512
    v_lshlrev_b32 v117, 2, v57
    ds_write_b32 v117, v17 offset:512
    v_lshlrev_b32 v118, 2, v58
    ds_write_b32 v118, v18 offset:512
    v_lshlrev_b32 v119, 2, v59
    ds_write_b32 v119, v19 offset:512
    v_lshlrev_b32 v120, 2, v60
    ds_write_b32 v120, v20 offset:512
    v_lshlrev_b32 v121, 2, v61
    ds_write_b32 v121, v21 offset:512
    v_lshlrev_b32 v122, 2, v62
    ds_write_b32 v122, v22 offset:512
    v_lshlrev_b32 v123, 2, v63
    ds_write_b32 v123, v23 offset:512
    v_lshlrev_b32 v116, 2, v64
    ds_write_b32 v116, v24 offset:512
    v_lshlrev_b32 v117, 2, v65
    ds_write_b32 v117, v25 offset:512
    v_lshlrev_b32 v118, 2, v66
    ds_write_b32 v118, v26 offset:512
    v_lshlrev_b32 v119, 2, v67
    ds_write_b32 v119, v27 offset:512
    v_lshlrev_b32 v120, 2, v68
    ds_write_b32 v120, v28 offset:512
    v_lshlrev_b32 v121, 2, v69
    ds_write_b32 v121, v29 offset:512
    v_lshlrev_b32 v122, 2, v70
    ds_write_b32 v122, v30 offset:512
    v_lshlrev_b32 v123, 2, v71
    ds_write_b32 v123, v31 offset:512
    v_lshlrev_b32 v116, 2, v72
    ds_write_b32 v116, v32 offset:512
    v_lshlrev_b32 v117, 2, v73
    ds_write_b32 v117, v33 offset:512
    v_lshlrev_b32 v118, 2, v74
    ds_write_b32 v118, v34 offset:512
    v_lshlrev_b32 v119, 2, v75
    ds_write_b32 v119, v35 offset:512
    v_lshlrev_b32 v120, 2, v76
    ds_write_b32 v120, v36 offset:512
    v_lshlrev_b32 v121, 2, v77
    ds_write_b32 v121, v37 offset:512
    v_lshlrev_b32 v122, 2, v78
    ds_write_b32 v122, v38 offset:512
    v_lshlrev_b32 v123, 2, v79
    ds_write_b32 v123, v39 offset:512
    v_lshlrev_b32 v116, 2, v80
    ds_write_b32 v116, v40 offset:512
    v_lshlrev_b32 v117, 2, v81
    ds_write_b32 v117, v41 offset:512
    v_lshlrev_b32 v118, 2, v82
    ds_write_b32 v118, v42 offset:512
    v_lshlrev_b32 v119, 2, v83
    ds_write_b32 v119, v43 offset:512
    v_lshlrev_b32 v120, 2, v84
    ds_write_b32 v120, v44 offset:512
    v_lshlrev_b32 v121, 2, v85
    ds_write_b32 v121, v45 offset:512
    v_lshlrev_b32 v122, 2, v86
    ds_write_b32 v122, v46 offset:512
    v_lshlrev_b32 v123, 2, v87
    ds_write_b32 v123, v47 offset:512
    s_mov_b64 exec, -1
    s_mov_b32 s38, 160000
    s_mov_b32 s66, 80000
    s_waitcnt lgkmcnt(0)
    s_barrier
    ds_read_b128 v[8:11], v1 offset:512
    ds_read_b128 v[12:15], v1 offset:16896
    ds_read_b128 v[16:19], v1 offset:33280
    ds_read_b128 v[20:23], v1 offset:49664
    ds_read_b128 v[24:27], v4 offset:512
    ds_read_b128 v[28:31], v4 offset:16896
    ds_read_b128 v[32:35], v4 offset:33280
    ds_read_b128 v[36:39], v4 offset:49664
    ds_read_b128 v[40:43], v5 offset:512
    ds_read_b128 v[44:47], v5 offset:16896
    s_waitcnt lgkmcnt(0)
    s_barrier
    s_mov_b64 exec, -1
    s_mov_b32 s48, 0
    buffer_store_dwordx4 v[8:11], v1, s[36:39], s48 offen sc1
    s_mov_b64 exec, s[50:51]
    s_waitcnt vmcnt(10)
    s_cmp_eq_u32 s16, 0x3f800000
    s_cbranch_scc0 k1_cg_2
    v_lshlrev_b32 v108, 16, v88
    v_and_b32 v109, v7, v88
    v_mul_f32 v108, 0.15915494, v108
    v_mul_f32 v109, 0.15915494, v109
    v_fract_f32 v108, v108
    v_fract_f32 v109, v109
    v_cos_f32 v108, v108
    v_cos_f32 v109, v109
    v_lshlrev_b32 v110, 16, v89
    v_and_b32 v111, v7, v89
    v_mul_f32 v110, 0.15915494, v110
    v_mul_f32 v111, 0.15915494, v111
    v_fract_f32 v110, v110
    v_fract_f32 v111, v111
    v_cos_f32 v110, v110
    v_cos_f32 v111, v111
    s_nop 0
    v_cvt_pk_bf16_f32 v88, v108, v109
    v_cvt_pk_bf16_f32 v89, v110, v111
    s_branch k1_cd_3
k1_cg_2:
    v_lshlrev_b32 v108, 16, v88
    v_and_b32 v109, v7, v88
    v_mul_f32 v108, s16, v108
    v_mul_f32 v109, s16, v109
    v_cvt_pk_bf16_f32 v108, v108, v109
    v_and_b32 v109, v7, v108
    v_lshlrev_b32 v108, 16, v108
    v_mul_f32 v108, 0.15915494, v108
    v_mul_f32 v109, 0.15915494, v109
    v_fract_f32 v108, v108
    v_fract_f32 v109, v109
    v_cos_f32 v108, v108
    v_cos_f32 v109, v109
    v_lshlrev_b32 v110, 16, v89
    v_and_b32 v111, v7, v89
    v_mul_f32 v110, s16, v110
    v_mul_f32 v111, s16, v111
    v_cvt_pk_bf16_f32 v110, v110, v111
    v_and_b32 v111, v7, v110
    v_lshlrev_b32 v110, 16, v110
    v_mul_f32 v110, 0.15915494, v110
    v_mul_f32 v111, 0.15915494, v111
    v_fract_f32 v110, v110
    v_fract_f32 v111, v111
    v_cos_f32 v110, v110
    v_cos_f32 v111, v111
    s_nop 0
    v_cvt_pk_bf16_f32 v88, v108, v109
    v_cvt_pk_bf16_f32 v89, v110, v111
k1_cd_3:
    v_add_u32 v116, v48, v48
    v_add_u32 v117, v49, v49
    ds_write_b16 v116, v88 offset:512
    ds_write_b16_d16_hi v117, v88 offset:512
    v_add_u32 v118, v50, v50
    v_add_u32 v119, v51, v51
    ds_write_b16 v118, v89 offset:512
    ds_write_b16_d16_hi v119, v89 offset:512
    s_mov_b64 exec, -1
    s_mov_b32 s48, 16384
    buffer_store_dwordx4 v[12:15], v1, s[36:39], s48 offen sc1
    s_mov_b64 exec, s[50:51]
    s_waitcnt vmcnt(10)
    s_cmp_eq_u32 s16, 0x3f800000
    s_cbranch_scc0 k1_cg_4
    v_lshlrev_b32 v108, 16, v90
    v_and_b32 v109, v7, v90
    v_mul_f32 v108, 0.15915494, v108
    v_mul_f32 v109, 0.15915494, v109
    v_fract_f32 v108, v108
    v_fract_f32 v109, v109
    v_cos_f32 v108, v108
    v_cos_f32 v109, v109
    v_lshlrev_b32 v110, 16, v91
    v_and_b32 v111, v7, v91
    v_mul_f32 v110, 0.15915494, v110
    v_mul_f32 v111, 0.15915494, v111
    v_fract_f32 v110, v110
    v_fract_f32 v111, v111
    v_cos_f32 v110, v110
    v_cos_f32 v111, v111
    s_nop 0
    v_cvt_pk_bf16_f32 v90, v108, v109
    v_cvt_pk_bf16_f32 v91, v110, v111
    s_branch k1_cd_5
k1_cg_4:
    v_lshlrev_b32 v108, 16, v90
    v_and_b32 v109, v7, v90
    v_mul_f32 v108, s16, v108
    v_mul_f32 v109, s16, v109
    v_cvt_pk_bf16_f32 v108, v108, v109
    v_and_b32 v109, v7, v108
    v_lshlrev_b32 v108, 16, v108
    v_mul_f32 v108, 0.15915494, v108
    v_mul_f32 v109, 0.15915494, v109
    v_fract_f32 v108, v108
    v_fract_f32 v109, v109
    v_cos_f32 v108, v108
    v_cos_f32 v109, v109
    v_lshlrev_b32 v110, 16, v91
    v_and_b32 v111, v7, v91
    v_mul_f32 v110, s16, v110
    v_mul_f32 v111, s16, v111
    v_cvt_pk_bf16_f32 v110, v110, v111
    v_and_b32 v111, v7, v110
    v_lshlrev_b32 v110, 16, v110
    v_mul_f32 v110, 0.15915494, v110
    v_mul_f32 v111, 0.15915494, v111
    v_fract_f32 v110, v110
    v_fract_f32 v111, v111
    v_cos_f32 v110, v110
    v_cos_f32 v111, v111
    s_nop 0
    v_cvt_pk_bf16_f32 v90, v108, v109
    v_cvt_pk_bf16_f32 v91, v110, v111
k1_cd_5:
    v_add_u32 v120, v52, v52
    v_add_u32 v121, v53, v53
    ds_write_b16 v120, v90 offset:512
    ds_write_b16_d16_hi v121, v90 offset:512
    v_add_u32 v122, v54, v54
    v_add_u32 v123, v55, v55
    ds_write_b16 v122, v91 offset:512
    ds_write_b16_d16_hi v123, v91 offset:512
    s_mov_b64 exec, -1
    s_mov_b32 s48, 32768
    buffer_store_dwordx4 v[16:19], v1, s[36:39], s48 offen sc1
    s_mov_b64 exec, s[50:51]
    s_waitcnt vmcnt(10)
    s_cmp_eq_u32 s16, 0x3f800000
    s_cbranch_scc0 k1_cg_6
    v_lshlrev_b32 v108, 16, v92
    v_and_b32 v109, v7, v92
    v_mul_f32 v108, 0.15915494, v108
    v_mul_f32 v109, 0.15915494, v109
    v_fract_f32 v108, v108
    v_fract_f32 v109, v109
    v_cos_f32 v108, v108
    v_cos_f32 v109, v109
    v_lshlrev_b32 v110, 16, v93
    v_and_b32 v111, v7, v93
    v_mul_f32 v110, 0.15915494, v110
    v_mul_f32 v111, 0.15915494, v111
    v_fract_f32 v110, v110
    v_fract_f32 v111, v111
    v_cos_f32 v110, v110
    v_cos_f32 v111, v111
    s_nop 0
    v_cvt_pk_bf16_f32 v92, v108, v109
    v_cvt_pk_bf16_f32 v93, v110, v111
    s_branch k1_cd_7
k1_cg_6:
    v_lshlrev_b32 v108, 16, v92
    v_and_b32 v109, v7, v92
    v_mul_f32 v108, s16, v108
    v_mul_f32 v109, s16, v109
    v_cvt_pk_bf16_f32 v108, v108, v109
    v_and_b32 v109, v7, v108
    v_lshlrev_b32 v108, 16, v108
    v_mul_f32 v108, 0.15915494, v108
    v_mul_f32 v109, 0.15915494, v109
    v_fract_f32 v108, v108
    v_fract_f32 v109, v109
    v_cos_f32 v108, v108
    v_cos_f32 v109, v109
    v_lshlrev_b32 v110, 16, v93
    v_and_b32 v111, v7, v93
    v_mul_f32 v110, s16, v110
    v_mul_f32 v111, s16, v111
    v_cvt_pk_bf16_f32 v110, v110, v111
    v_and_b32 v111, v7, v110
    v_lshlrev_b32 v110, 16, v110
    v_mul_f32 v110, 0.15915494, v110
    v_mul_f32 v111, 0.15915494, v111
    v_fract_f32 v110, v110
    v_fract_f32 v111, v111
    v_cos_f32 v110, v110
    v_cos_f32 v111, v111
    s_nop 0
    v_cvt_pk_bf16_f32 v92, v108, v109
    v_cvt_pk_bf16_f32 v93, v110, v111
k1_cd_7:
    v_add_u32 v116, v56, v56
    v_add_u32 v117, v57, v57
    ds_write_b16 v116, v92 offset:512
    ds_write_b16_d16_hi v117, v92 offset:512
    v_add_u32 v118, v58, v58
    v_add_u32 v119, v59, v59
    ds_write_b16 v118, v93 offset:512
    ds_write_b16_d16_hi v119, v93 offset:512
    s_mov_b64 exec, -1
    s_mov_b32 s48, 49152
    buffer_store_dwordx4 v[20:23], v1, s[36:39], s48 offen sc1
    s_mov_b64 exec, s[50:51]
    s_waitcnt vmcnt(10)
    s_cmp_eq_u32 s16, 0x3f800000
    s_cbranch_scc0 k1_cg_8
    v_lshlrev_b32 v108, 16, v94
    v_and_b32 v109, v7, v94
    v_mul_f32 v108, 0.15915494, v108
    v_mul_f32 v109, 0.15915494, v109
    v_fract_f32 v108, v108
    v_fract_f32 v109, v109
    v_cos_f32 v108, v108
    v_cos_f32 v109, v109
    v_lshlrev_b32 v110, 16, v95
    v_and_b32 v111, v7, v95
    v_mul_f32 v110, 0.15915494, v110
    v_mul_f32 v111, 0.15915494, v111
    v_fract_f32 v110, v110
    v_fract_f32 v111, v111
    v_cos_f32 v110, v110
    v_cos_f32 v111, v111
    s_nop 0
    v_cvt_pk_bf16_f32 v94, v108, v109
    v_cvt_pk_bf16_f32 v95, v110, v111
    s_branch k1_cd_9
k1_cg_8:
    v_lshlrev_b32 v108, 16, v94
    v_and_b32 v109, v7, v94
    v_mul_f32 v108, s16, v108
    v_mul_f32 v109, s16, v109
    v_cvt_pk_bf16_f32 v108, v108, v109
    v_and_b32 v109, v7, v108
    v_lshlrev_b32 v108, 16, v108
    v_mul_f32 v108, 0.15915494, v108
    v_mul_f32 v109, 0.15915494, v109
    v_fract_f32 v108, v108
    v_fract_f32 v109, v109
    v_cos_f32 v108, v108
    v_cos_f32 v109, v109
    v_lshlrev_b32 v110, 16, v95
    v_and_b32 v111, v7, v95
    v_mul_f32 v110, s16, v110
    v_mul_f32 v111, s16, v111
    v_cvt_pk_bf16_f32 v110, v110, v111
    v_and_b32 v111, v7, v110
    v_lshlrev_b32 v110, 16, v110
    v_mul_f32 v110, 0.15915494, v110
    v_mul_f32 v111, 0.15915494, v111
    v_fract_f32 v110, v110
    v_fract_f32 v111, v111
    v_cos_f32 v110, v110
    v_cos_f32 v111, v111
    s_nop 0
    v_cvt_pk_bf16_f32 v94, v108, v109
    v_cvt_pk_bf16_f32 v95, v110, v111
k1_cd_9:
    v_add_u32 v120, v60, v60
    v_add_u32 v121, v61, v61
    ds_write_b16 v120, v94 offset:512
    ds_write_b16_d16_hi v121, v94 offset:512
    v_add_u32 v122, v62, v62
    v_add_u32 v123, v63, v63
    ds_write_b16 v122, v95 offset:512
    ds_write_b16_d16_hi v123, v95 offset:512
    s_mov_b64 exec, -1
    s_mov_b32 s48, 65536
    buffer_store_dwordx4 v[24:27], v1, s[36:39], s48 offen sc1
    s_mov_b64 exec, s[50:51]
    s_waitcnt vmcnt(10)
    s_cmp_eq_u32 s16, 0x3f800000
    s_cbranch_scc0 k1_cg_10
    v_lshlrev_b32 v108, 16, v96
    v_and_b32 v109, v7, v96
    v_mul_f32 v108, 0.15915494, v108
    v_mul_f32 v109, 0.15915494, v109
    v_fract_f32 v108, v108
    v_fract_f32 v109, v109
    v_cos_f32 v108, v108
    v_cos_f32 v109, v109
    v_lshlrev_b32 v110, 16, v97
    v_and_b32 v111, v7, v97
    v_mul_f32 v110, 0.15915494, v110
    v_mul_f32 v111, 0.15915494, v111
    v_fract_f32 v110, v110
    v_fract_f32 v111, v111
    v_cos_f32 v110, v110
    v_cos_f32 v111, v111
    s_nop 0
    v_cvt_pk_bf16_f32 v96, v108, v109
    v_cvt_pk_bf16_f32 v97, v110, v111
    s_branch k1_cd_11
k1_cg_10:
    v_lshlrev_b32 v108, 16, v96
    v_and_b32 v109, v7, v96
    v_mul_f32 v108, s16, v108
    v_mul_f32 v109, s16, v109
    v_cvt_pk_bf16_f32 v108, v108, v109
    v_and_b32 v109, v7, v108
    v_lshlrev_b32 v108, 16, v108
    v_mul_f32 v108, 0.15915494, v108
    v_mul_f32 v109, 0.15915494, v109
    v_fract_f32 v108, v108
    v_fract_f32 v109, v109
    v_cos_f32 v108, v108
    v_cos_f32 v109, v109
    v_lshlrev_b32 v110, 16, v97
    v_and_b32 v111, v7, v97
    v_mul_f32 v110, s16, v110
    v_mul_f32 v111, s16, v111
    v_cvt_pk_bf16_f32 v110, v110, v111
    v_and_b32 v111, v7, v110
    v_lshlrev_b32 v110, 16, v110
    v_mul_f32 v110, 0.15915494, v110
    v_mul_f32 v111, 0.15915494, v111
    v_fract_f32 v110, v110
    v_fract_f32 v111, v111
    v_cos_f32 v110, v110
    v_cos_f32 v111, v111
    s_nop 0
    v_cvt_pk_bf16_f32 v96, v108, v109
    v_cvt_pk_bf16_f32 v97, v110, v111
k1_cd_11:
    v_add_u32 v116, v64, v64
    v_add_u32 v117, v65, v65
    ds_write_b16 v116, v96 offset:512
    ds_write_b16_d16_hi v117, v96 offset:512
    v_add_u32 v118, v66, v66
    v_add_u32 v119, v67, v67
    ds_write_b16 v118, v97 offset:512
    ds_write_b16_d16_hi v119, v97 offset:512
    s_mov_b64 exec, -1
    s_mov_b32 s48, 81920
    buffer_store_dwordx4 v[28:31], v1, s[36:39], s48 offen sc1
    s_mov_b64 exec, s[50:51]
    s_waitcnt vmcnt(10)
    s_cmp_eq_u32 s16, 0x3f800000
    s_cbranch_scc0 k1_cg_12
    v_lshlrev_b32 v108, 16, v98
    v_and_b32 v109, v7, v98
    v_mul_f32 v108, 0.15915494, v108
    v_mul_f32 v109, 0.15915494, v109
    v_fract_f32 v108, v108
    v_fract_f32 v109, v109
    v_cos_f32 v108, v108
    v_cos_f32 v109, v109
    v_lshlrev_b32 v110, 16, v99
    v_and_b32 v111, v7, v99
    v_mul_f32 v110, 0.15915494, v110
    v_mul_f32 v111, 0.15915494, v111
    v_fract_f32 v110, v110
    v_fract_f32 v111, v111
    v_cos_f32 v110, v110
    v_cos_f32 v111, v111
    s_nop 0
    v_cvt_pk_bf16_f32 v98, v108, v109
    v_cvt_pk_bf16_f32 v99, v110, v111
    s_branch k1_cd_13
k1_cg_12:
    v_lshlrev_b32 v108, 16, v98
    v_and_b32 v109, v7, v98
    v_mul_f32 v108, s16, v108
    v_mul_f32 v109, s16, v109
    v_cvt_pk_bf16_f32 v108, v108, v109
    v_and_b32 v109, v7, v108
    v_lshlrev_b32 v108, 16, v108
    v_mul_f32 v108, 0.15915494, v108
    v_mul_f32 v109, 0.15915494, v109
    v_fract_f32 v108, v108
    v_fract_f32 v109, v109
    v_cos_f32 v108, v108
    v_cos_f32 v109, v109
    v_lshlrev_b32 v110, 16, v99
    v_and_b32 v111, v7, v99
    v_mul_f32 v110, s16, v110
    v_mul_f32 v111, s16, v111
    v_cvt_pk_bf16_f32 v110, v110, v111
    v_and_b32 v111, v7, v110
    v_lshlrev_b32 v110, 16, v110
    v_mul_f32 v110, 0.15915494, v110
    v_mul_f32 v111, 0.15915494, v111
    v_fract_f32 v110, v110
    v_fract_f32 v111, v111
    v_cos_f32 v110, v110
    v_cos_f32 v111, v111
    s_nop 0
    v_cvt_pk_bf16_f32 v98, v108, v109
    v_cvt_pk_bf16_f32 v99, v110, v111
k1_cd_13:
    v_add_u32 v120, v68, v68
    v_add_u32 v121, v69, v69
    ds_write_b16 v120, v98 offset:512
    ds_write_b16_d16_hi v121, v98 offset:512
    v_add_u32 v122, v70, v70
    v_add_u32 v123, v71, v71
    ds_write_b16 v122, v99 offset:512
    ds_write_b16_d16_hi v123, v99 offset:512
    s_mov_b64 exec, -1
    s_mov_b32 s48, 98304
    buffer_store_dwordx4 v[32:35], v1, s[36:39], s48 offen sc1
    s_mov_b64 exec, s[50:51]
    s_waitcnt vmcnt(10)
    s_cmp_eq_u32 s16, 0x3f800000
    s_cbranch_scc0 k1_cg_14
    v_lshlrev_b32 v108, 16, v100
    v_and_b32 v109, v7, v100
    v_mul_f32 v108, 0.15915494, v108
    v_mul_f32 v109, 0.15915494, v109
    v_fract_f32 v108, v108
    v_fract_f32 v109, v109
    v_cos_f32 v108, v108
    v_cos_f32 v109, v109
    v_lshlrev_b32 v110, 16, v101
    v_and_b32 v111, v7, v101
    v_mul_f32 v110, 0.15915494, v110
    v_mul_f32 v111, 0.15915494, v111
    v_fract_f32 v110, v110
    v_fract_f32 v111, v111
    v_cos_f32 v110, v110
    v_cos_f32 v111, v111
    s_nop 0
    v_cvt_pk_bf16_f32 v100, v108, v109
    v_cvt_pk_bf16_f32 v101, v110, v111
    s_branch k1_cd_15
k1_cg_14:
    v_lshlrev_b32 v108, 16, v100
    v_and_b32 v109, v7, v100
    v_mul_f32 v108, s16, v108
    v_mul_f32 v109, s16, v109
    v_cvt_pk_bf16_f32 v108, v108, v109
    v_and_b32 v109, v7, v108
    v_lshlrev_b32 v108, 16, v108
    v_mul_f32 v108, 0.15915494, v108
    v_mul_f32 v109, 0.15915494, v109
    v_fract_f32 v108, v108
    v_fract_f32 v109, v109
    v_cos_f32 v108, v108
    v_cos_f32 v109, v109
    v_lshlrev_b32 v110, 16, v101
    v_and_b32 v111, v7, v101
    v_mul_f32 v110, s16, v110
    v_mul_f32 v111, s16, v111
    v_cvt_pk_bf16_f32 v110, v110, v111
    v_and_b32 v111, v7, v110
    v_lshlrev_b32 v110, 16, v110
    v_mul_f32 v110, 0.15915494, v110
    v_mul_f32 v111, 0.15915494, v111
    v_fract_f32 v110, v110
    v_fract_f32 v111, v111
    v_cos_f32 v110, v110
    v_cos_f32 v111, v111
    s_nop 0
    v_cvt_pk_bf16_f32 v100, v108, v109
    v_cvt_pk_bf16_f32 v101, v110, v111
k1_cd_15:
    v_add_u32 v116, v72, v72
    v_add_u32 v117, v73, v73
    ds_write_b16 v116, v100 offset:512
    ds_write_b16_d16_hi v117, v100 offset:512
    v_add_u32 v118, v74, v74
    v_add_u32 v119, v75, v75
    ds_write_b16 v118, v101 offset:512
    ds_write_b16_d16_hi v119, v101 offset:512
    s_mov_b64 exec, -1
    s_mov_b32 s48, 114688
    buffer_store_dwordx4 v[36:39], v1, s[36:39], s48 offen sc1
    s_mov_b64 exec, s[50:51]
    s_waitcnt vmcnt(10)
    s_cmp_eq_u32 s16, 0x3f800000
    s_cbranch_scc0 k1_cg_16
    v_lshlrev_b32 v108, 16, v102
    v_and_b32 v109, v7, v102
    v_mul_f32 v108, 0.15915494, v108
    v_mul_f32 v109, 0.15915494, v109
    v_fract_f32 v108, v108
    v_fract_f32 v109, v109
    v_cos_f32 v108, v108
    v_cos_f32 v109, v109
    v_lshlrev_b32 v110, 16, v103
    v_and_b32 v111, v7, v103
    v_mul_f32 v110, 0.15915494, v110
    v_mul_f32 v111, 0.15915494, v111
    v_fract_f32 v110, v110
    v_fract_f32 v111, v111
    v_cos_f32 v110, v110
    v_cos_f32 v111, v111
    s_nop 0
    v_cvt_pk_bf16_f32 v102, v108, v109
    v_cvt_pk_bf16_f32 v103, v110, v111
    s_branch k1_cd_17
k1_cg_16:
    v_lshlrev_b32 v108, 16, v102
    v_and_b32 v109, v7, v102
    v_mul_f32 v108, s16, v108
    v_mul_f32 v109, s16, v109
    v_cvt_pk_bf16_f32 v108, v108, v109
    v_and_b32 v109, v7, v108
    v_lshlrev_b32 v108, 16, v108
    v_mul_f32 v108, 0.15915494, v108
    v_mul_f32 v109, 0.15915494, v109
    v_fract_f32 v108, v108
    v_fract_f32 v109, v109
    v_cos_f32 v108, v108
    v_cos_f32 v109, v109
    v_lshlrev_b32 v110, 16, v103
    v_and_b32 v111, v7, v103
    v_mul_f32 v110, s16, v110
    v_mul_f32 v111, s16, v111
    v_cvt_pk_bf16_f32 v110, v110, v111
    v_and_b32 v111, v7, v110
    v_lshlrev_b32 v110, 16, v110
    v_mul_f32 v110, 0.15915494, v110
    v_mul_f32 v111, 0.15915494, v111
    v_fract_f32 v110, v110
    v_fract_f32 v111, v111
    v_cos_f32 v110, v110
    v_cos_f32 v111, v111
    s_nop 0
    v_cvt_pk_bf16_f32 v102, v108, v109
    v_cvt_pk_bf16_f32 v103, v110, v111
k1_cd_17:
    v_add_u32 v120, v76, v76
    v_add_u32 v121, v77, v77
    ds_write_b16 v120, v102 offset:512
    ds_write_b16_d16_hi v121, v102 offset:512
    v_add_u32 v122, v78, v78
    v_add_u32 v123, v79, v79
    ds_write_b16 v122, v103 offset:512
    ds_write_b16_d16_hi v123, v103 offset:512
    s_mov_b64 exec, -1
    s_mov_b32 s48, 131072
    buffer_store_dwordx4 v[40:43], v1, s[36:39], s48 offen sc1
    s_mov_b64 exec, s[50:51]
    s_waitcnt vmcnt(10)
    s_cmp_eq_u32 s16, 0x3f800000
    s_cbranch_scc0 k1_cg_18
    v_lshlrev_b32 v108, 16, v104
    v_and_b32 v109, v7, v104
    v_mul_f32 v108, 0.15915494, v108
    v_mul_f32 v109, 0.15915494, v109
    v_fract_f32 v108, v108
    v_fract_f32 v109, v109
    v_cos_f32 v108, v108
    v_cos_f32 v109, v109
    v_lshlrev_b32 v110, 16, v105
    v_and_b32 v111, v7, v105
    v_mul_f32 v110, 0.15915494, v110
    v_mul_f32 v111, 0.15915494, v111
    v_fract_f32 v110, v110
    v_fract_f32 v111, v111
    v_cos_f32 v110, v110
    v_cos_f32 v111, v111
    s_nop 0
    v_cvt_pk_bf16_f32 v104, v108, v109
    v_cvt_pk_bf16_f32 v105, v110, v111
    s_branch k1_cd_19
k1_cg_18:
    v_lshlrev_b32 v108, 16, v104
    v_and_b32 v109, v7, v104
    v_mul_f32 v108, s16, v108
    v_mul_f32 v109, s16, v109
    v_cvt_pk_bf16_f32 v108, v108, v109
    v_and_b32 v109, v7, v108
    v_lshlrev_b32 v108, 16, v108
    v_mul_f32 v108, 0.15915494, v108
    v_mul_f32 v109, 0.15915494, v109
    v_fract_f32 v108, v108
    v_fract_f32 v109, v109
    v_cos_f32 v108, v108
    v_cos_f32 v109, v109
    v_lshlrev_b32 v110, 16, v105
    v_and_b32 v111, v7, v105
    v_mul_f32 v110, s16, v110
    v_mul_f32 v111, s16, v111
    v_cvt_pk_bf16_f32 v110, v110, v111
    v_and_b32 v111, v7, v110
    v_lshlrev_b32 v110, 16, v110
    v_mul_f32 v110, 0.15915494, v110
    v_mul_f32 v111, 0.15915494, v111
    v_fract_f32 v110, v110
    v_fract_f32 v111, v111
    v_cos_f32 v110, v110
    v_cos_f32 v111, v111
    s_nop 0
    v_cvt_pk_bf16_f32 v104, v108, v109
    v_cvt_pk_bf16_f32 v105, v110, v111
k1_cd_19:
    v_add_u32 v116, v80, v80
    v_add_u32 v117, v81, v81
    ds_write_b16 v116, v104 offset:512
    ds_write_b16_d16_hi v117, v104 offset:512
    v_add_u32 v118, v82, v82
    v_add_u32 v119, v83, v83
    ds_write_b16 v118, v105 offset:512
    ds_write_b16_d16_hi v119, v105 offset:512
    s_mov_b64 exec, -1
    s_mov_b32 s48, 147456
    buffer_store_dwordx4 v[44:47], v1, s[36:39], s48 offen sc1
    s_mov_b64 exec, s[50:51]
    s_waitcnt vmcnt(10)
    s_cmp_eq_u32 s16, 0x3f800000
    s_cbranch_scc0 k1_cg_20
    v_lshlrev_b32 v108, 16, v106
    v_and_b32 v109, v7, v106
    v_mul_f32 v108, 0.15915494, v108
    v_mul_f32 v109, 0.15915494, v109
    v_fract_f32 v108, v108
    v_fract_f32 v109, v109
    v_cos_f32 v108, v108
    v_cos_f32 v109, v109
    v_lshlrev_b32 v110, 16, v107
    v_and_b32 v111, v7, v107
    v_mul_f32 v110, 0.15915494, v110
    v_mul_f32 v111, 0.15915494, v111
    v_fract_f32 v110, v110
    v_fract_f32 v111, v111
    v_cos_f32 v110, v110
    v_cos_f32 v111, v111
    s_nop 0
    v_cvt_pk_bf16_f32 v106, v108, v109
    v_cvt_pk_bf16_f32 v107, v110, v111
    s_branch k1_cd_21
k1_cg_20:
    v_lshlrev_b32 v108, 16, v106
    v_and_b32 v109, v7, v106
    v_mul_f32 v108, s16, v108
    v_mul_f32 v109, s16, v109
    v_cvt_pk_bf16_f32 v108, v108, v109
    v_and_b32 v109, v7, v108
    v_lshlrev_b32 v108, 16, v108
    v_mul_f32 v108, 0.15915494, v108
    v_mul_f32 v109, 0.15915494, v109
    v_fract_f32 v108, v108
    v_fract_f32 v109, v109
    v_cos_f32 v108, v108
    v_cos_f32 v109, v109
    v_lshlrev_b32 v110, 16, v107
    v_and_b32 v111, v7, v107
    v_mul_f32 v110, s16, v110
    v_mul_f32 v111, s16, v111
    v_cvt_pk_bf16_f32 v110, v110, v111
    v_and_b32 v111, v7, v110
    v_lshlrev_b32 v110, 16, v110
    v_mul_f32 v110, 0.15915494, v110
    v_mul_f32 v111, 0.15915494, v111
    v_fract_f32 v110, v110
    v_fract_f32 v111, v111
    v_cos_f32 v110, v110
    v_cos_f32 v111, v111
    s_nop 0
    v_cvt_pk_bf16_f32 v106, v108, v109
    v_cvt_pk_bf16_f32 v107, v110, v111
k1_cd_21:
    v_add_u32 v120, v84, v84
    v_add_u32 v121, v85, v85
    ds_write_b16 v120, v106 offset:512
    ds_write_b16_d16_hi v121, v106 offset:512
    v_add_u32 v122, v86, v86
    v_add_u32 v123, v87, v87
    ds_write_b16 v122, v107 offset:512
    ds_write_b16_d16_hi v123, v107 offset:512
    s_mov_b64 exec, -1
    s_cmp_ge_u32 s49, 12
    s_cbranch_scc1 k1_notab
    v_and_b32 v6, 63, v0
    v_mul_u32_u24 v6, 192, v6
    s_lshl_b32 s17, s49, 2
    s_add_u32 s17, s17, 82432
    v_add_u32 v6, s17, v6
    ds_write_b32 v6, v124 offset:0
    ds_write_b32 v6, v125 offset:48
    ds_write_b32 v6, v126 offset:96
    ds_write_b32 v6, v127 offset:144
k1_notab:
    s_waitcnt lgkmcnt(0)
    s_barrier
    ds_read_b128 v[8:11], v1 offset:512
    ds_read_b128 v[12:15], v1 offset:16896
    ds_read_b128 v[16:19], v1 offset:33280
    ds_read_b128 v[20:23], v1 offset:49664
    ds_read_b128 v[24:27], v4 offset:512
    s_cmp_gt_u32 s49, 12
    s_cbranch_scc1 k1_tabdone
    s_cmp_eq_u32 s49, 12
    s_cbranch_scc1 k1_maxout
    v_add_u32 v112, 82432, v1
    ds_read_b128 v[108:111], v112
    s_waitcnt lgkmcnt(0)
    buffer_store_dwordx4 v[108:111], v1, s[40:43], 0 offen sc1
    s_branch k1_tabdone
k1_maxout:
    v_and_b32 v108, 63, v0
    v_lshlrev_b32 v108, 2, v108
    ds_read_b32 v109, v108 offset:128
    s_waitcnt lgkmcnt(0)
    buffer_store_dword v109, v108, s[44:47], 0 offen sc1
k1_tabdone:
    s_waitcnt lgkmcnt(0)
    s_mov_b32 s48, 0
    buffer_store_dwordx4 v[8:11], v1, s[64:67], s48 offen sc1
    s_mov_b32 s48, 16384
    buffer_store_dwordx4 v[12:15], v1, s[64:67], s48 offen sc1
    s_mov_b32 s48, 32768
    buffer_store_dwordx4 v[16:19], v1, s[64:67], s48 offen sc1
    s_mov_b32 s48, 49152
    buffer_store_dwordx4 v[20:23], v1, s[64:67], s48 offen sc1
    s_mov_b32 s48, 65536
    buffer_store_dwordx4 v[24:27], v1, s[64:67], s48 offen sc1
k1_end:
    s_endpgm
.p2align 8
.type k2_kernel,@function
k2_kernel:
    s_cmp_ge_u32 s2, 256
    s_cbranch_scc1 k2_end
    s_load_dwordx2 s[4:5], s[0:1], 0
    s_load_dwordx2 s[6:7], s[0:1], 104
    s_load_dwordx2 s[8:9], s[0:1], 24
    s_load_dwordx2 s[10:11], s[0:1], 88
    s_load_dwordx2 s[12:13], s[0:1], 40
    s_load_dwordx4 s[16:19], s[0:1], 56
    s_load_dwordx4 s[96:99], s[0:1], 72
    s_and_b32 s80, s2, 7
    s_lshl_b32 s80, s80, 5
    s_lshr_b32 s81, s2, 3
    s_add_u32 s88, s80, s81
    s_lshr_b32 s86, s88, 6
    s_and_b32 s87, s88, 63
    v_lshlrev_b32 v1, 4, v0
    v_readfirstlane_b32 s84, v0
    v_lshrrev_b32 v76, 6, v0
    v_lshlrev_b32 v76, 4, v76
    v_and_b32 v77, 15, v0
    v_or_b32 v76, v76, v77
    v_bfe_u32 v78, v0, 4, 2
    v_mul_u32_u24 v79, 12288, v76
    v_mad_u32_u24 v79, v78, 12, v79
    v_and_b32 v25, 63, v0
    v_lshlrev_b32 v25, 6, v25
    s_lshr_b32 s84, s84, 6
    s_mul_i32 s80, s88, 48
    s_waitcnt lgkmcnt(0)
    s_add_u32 s28, s6, s80
    s_addc_u32 s29, s7, 0
    s_add_u32 s28, s28, 100663296
    s_addc_u32 s29, s29, 0
    s_and_b32 s29, s29, 0xffff
    s_mov_b32 s30, 0
    s_mov_b32 s31, 0x20000
    s_sub_u32 s30, 3145728, s80
    buffer_load_dwordx3 v[2:4], v79, s[28:31], 0 offen
    s_add_u32 s32, s6, 103809024
    s_addc_u32 s33, s7, 0
    s_and_b32 s33, s33, 0xffff
    s_mov_b32 s34, 4096
    s_mov_b32 s35, 0x20000
    s_mov_b32 s20, s4
    s_mov_b32 s21, s5
    s_and_b32 s21, s21, 0xffff
    s_mov_b32 s22, 2560000
    s_mov_b32 s23, 0x20000
    v_add_u32 v13, 80000, v1
    s_mul_i32 s91, s86, 53760
    s_add_u32 s92, s91, 0
    buffer_load_dwordx4 v[106:109], v1, s[20:23], s92 offen
k2_lp_22:
    s_mov_b32 s24, s6
    s_mov_b32 s25, s7
    s_and_b32 s25, s25, 0xffff
    s_mov_b32 s26, 67108864
    s_mov_b32 s27, 0x20000
    s_add_u32 s76, s6, 67108864
    s_addc_u32 s77, s7, 0
    s_and_b32 s77, s77, 0xffff
    s_mov_b32 s78, 33554432
    s_mov_b32 s79, 0x20000
    s_mul_i32 s80, s86, 5120000
    s_mul_i32 s81, s87, 80000
    s_add_u32 s80, s80, s81
    s_add_u32 s36, s6, s80
    s_addc_u32 s37, s7, 0
    s_add_u32 s36, s36, 103829760
    s_addc_u32 s37, s37, 0
    s_and_b32 s37, s37, 0xffff
    s_mov_b32 s38, 80000
    s_mov_b32 s39, 0x20000
    v_lshlrev_b32 v19, 18, v76
    v_mul_u32_u24 v20, 3, v78
    v_lshlrev_b32 v21, 8, v20
    v_add_lshl_u32 v21, v21, v76, 2
    v_add_u32 v21, 142464, v21
    v_lshlrev_b32 v22, 6, v20
    v_lshlrev_b32 v23, 2, v77
    v_add3_u32 v23, v23, v22, 0
    v_add_u32 v23, 154752, v23
    v_mov_b32 v24, v77
    v_lshrrev_b32 v14, 2, v0
    v_lshlrev_b32 v17, 2, v14
    v_add_u32 v17, 142464, v17
    v_lshlrev_b32 v14, 18, v14
    v_and_b32 v15, 3, v0
    v_lshlrev_b32 v16, 2, v15
    v_lshl_add_u32 v14, v15, 4, v14
    v_mov_b32 v80, 0x40000000
    v_mov_b32 v81, 0x40000000
    v_mov_b32 v82, 0x40000000
    v_mov_b32 v83, 0x40000000
    ds_write_b128 v1, v[80:83] offset:0
    ds_write_b128 v1, v[80:83] offset:16384
    ds_write_b128 v1, v[80:83] offset:32768
    ds_write_b128 v1, v[80:83] offset:49152
    v_add_u32 v78, 0x10000, v1
    v_cmp_gt_u32 vcc, 904, v0
    s_and_saveexec_b64 s[80:81], vcc
    ds_write_b128 v78, v[80:83]
    s_mov_b64 exec, s[80:81]
    v_mov_b32 v84, 155776
    v_mov_b32 v85, 0
    ds_write2_b32 v84, v85, v85 offset0:0 offset1:3
    v_mov_b32 v100, 0
    v_mov_b32 v101, 80000
    v_mov_b32 v103, 0xffff0000
    v_mov_b32 v105, 0x4b400000
    v_lshlrev_b32 v102, 2, v0
    s_waitcnt vmcnt(1)
    s_mul_i32 s91, s86, 53760
    s_add_u32 s92, s91, 16384
    buffer_load_dwordx4 v[110:113], v1, s[20:23], s92 offen
k2_lp_23:
    s_cmp_lg_u32 s84, 15
    s_cbranch_scc1 k2_nomax
    buffer_load_dwordx4 v[36:39], v25, s[32:35], 0 offen offset:0
    buffer_load_dwordx4 v[40:43], v25, s[32:35], 0 offen offset:16
    buffer_load_dwordx4 v[44:47], v25, s[32:35], 0 offen offset:32
    buffer_load_dwordx4 v[48:51], v25, s[32:35], 0 offen offset:48
k2_nomax:
    v_lshrrev_b32 v76, 16, v2
    v_lshrrev_b32 v77, 16, v3
    v_lshrrev_b32 v78, 16, v4
    v_max3_u32 v79, v76, v77, v78
    v_add_u32 v10, 3, v76
    v_add_u32 v11, 3, v77
    v_add_u32 v12, 3, v78
    v_lshrrev_b32 v10, 2, v10
    v_lshrrev_b32 v11, 2, v11
    v_lshrrev_b32 v12, 2, v12
    v_mov_b32 v6, v10
    v_mov_b32 v7, v11
    v_mov_b32 v8, v12
    v_cmp_lt_u32 vcc, 63, v79
    s_nop 1
    v_add_u32_dpp v6, v6, v6 row_shr:1 row_mask:0xf bank_mask:0xf
    v_add_u32_dpp v7, v7, v7 row_shr:1 row_mask:0xf bank_mask:0xf
    v_add_u32_dpp v8, v8, v8 row_shr:1 row_mask:0xf bank_mask:0xf
    v_add_u32_dpp v6, v6, v6 row_shr:2 row_mask:0xf bank_mask:0xf
    v_add_u32_dpp v7, v7, v7 row_shr:2 row_mask:0xf bank_mask:0xf
    v_add_u32_dpp v8, v8, v8 row_shr:2 row_mask:0xf bank_mask:0xf
    v_add_u32_dpp v6, v6, v6 row_shr:4 row_mask:0xf bank_mask:0xf
    v_add_u32_dpp v7, v7, v7 row_shr:4 row_mask:0xf bank_mask:0xf
    v_add_u32_dpp v8, v8, v8 row_shr:4 row_mask:0xf bank_mask:0xf
    v_add_u32_dpp v6, v6, v6 row_shr:8 row_mask:0xf bank_mask:0xf
    v_add_u32_dpp v7, v7, v7 row_shr:8 row_mask:0xf bank_mask:0xf
    v_add_u32_dpp v8, v8, v8 row_shr:8 row_mask:0xf bank_mask:0xf
    s_nop 1
    s_lshl_b32 s90, s84, 2
    v_add_u32 v80, s90, v22
    v_add_u32 v80, 154752, v80
    s_mov_b64 s[80:81], vcc
    s_mov_b32 exec_lo, 0x80008000
    s_mov_b32 exec_hi, 0x80008000
    ds_write_b32 v80, v6 offset:0
    ds_write_b32 v80, v7 offset:64
    ds_write_b32 v80, v8 offset:128
    s_mov_b64 exec, -1
    v_sub_u32 v6, v6, v10
    v_sub_u32 v7, v7, v11
    v_sub_u32 v8, v8, v12
    s_waitcnt lgkmcnt(0)
    s_barrier
    s_mul_i32 s91, s86, 53760
    s_add_u32 s92, s91, 32768
    buffer_load_dwordx4 v[114:117], v1, s[20:23], s92 offen
k2_lp_24:
    s_mul_i32 s91, s86, 53760
    s_add_u32 s92, s91, 215040
    buffer_load_dwordx4 v[60:63], v1, s[20:23], s92 offen
k2_lp_25:
    s_cmp_eq_u64 s[80:81], 0
    s_cbranch_scc1 k2_nobig
    v_mov_b32 v85, 1
    ds_write_b32 v84, v85 offset:12
k2_nobig:
    ds_read_b32 v28, v23 offset:0
    ds_read_b32 v29, v23 offset:64
    ds_read_b32 v30, v23 offset:128
    v_mov_b32 v32, 0
    v_mov_b32 v33, 0
    v_mov_b32 v34, 0
    v_cmp_gt_u32 vcc, s84, v24
    s_waitcnt lgkmcnt(0)
    s_mov_b64 exec, vcc
    v_mov_b32 v32, v28
    v_mov_b32 v33, v29
    v_mov_b32 v34, v30
    s_mov_b64 exec, -1
    s_nop 1
    v_add_u32_dpp v28, v28, v28 row_ror:8 row_mask:0xf bank_mask:0xf
    v_add_u32_dpp v29, v29, v29 row_ror:8 row_mask:0xf bank_mask:0xf
    v_add_u32_dpp v30, v30, v30 row_ror:8 row_mask:0xf bank_mask:0xf
    v_add_u32_dpp v32, v32, v32 row_ror:8 row_mask:0xf bank_mask:0xf
    v_add_u32_dpp v33, v33, v33 row_ror:8 row_mask:0xf bank_mask:0xf
    v_add_u32_dpp v34, v34, v34 row_ror:8 row_mask:0xf bank_mask:0xf
    s_nop 1
    v_add_u32_dpp v28, v28, v28 row_ror:4 row_mask:0xf bank_mask:0xf
    v_add_u32_dpp v29, v29, v29 row_ror:4 row_mask:0xf bank_mask:0xf
    v_add_u32_dpp v30, v30, v30 row_ror:4 row_mask:0xf bank_mask:0xf
    v_add_u32_dpp v32, v32, v32 row_ror:4 row_mask:0xf bank_mask:0xf
    v_add_u32_dpp v33, v33, v33 row_ror:4 row_mask:0xf bank_mask:0xf
    v_add_u32_dpp v34, v34, v34 row_ror:4 row_mask:0xf bank_mask:0xf
    s_nop 1
    v_add_u32_dpp v28, v28, v28 row_ror:2 row_mask:0xf bank_mask:0xf
    v_add_u32_dpp v29, v29, v29 row_ror:2 row_mask:0xf bank_mask:0xf
    v_add_u32_dpp v30, v30, v30 row_ror:2 row_mask:0xf bank_mask:0xf
    v_add_u32_dpp v32, v32, v32 row_ror:2 row_mask:0xf bank_mask:0xf
    v_add_u32_dpp v33, v33, v33 row_ror:2 row_mask:0xf bank_mask:0xf
    v_add_u32_dpp v34, v34, v34 row_ror:2 row_mask:0xf bank_mask:0xf
    s_nop 1
    v_add_u32_dpp v28, v28, v28 row_ror:1 row_mask:0xf bank_mask:0xf
    v_add_u32_dpp v29, v29, v29 row_ror:1 row_mask:0xf bank_mask:0xf
    v_add_u32_dpp v30, v30, v30 row_ror:1 row_mask:0xf bank_mask:0xf
    v_add_u32_dpp v32, v32, v32 row_ror:1 row_mask:0xf bank_mask:0xf
    v_add_u32_dpp v33, v33, v33 row_ror:1 row_mask:0xf bank_mask:0xf
    v_add_u32_dpp v34, v34, v34 row_ror:1 row_mask:0xf bank_mask:0xf
    s_nop 1
    v_add_u32 v6, v6, v32
    v_add_u32 v7, v7, v33
    v_add_u32 v8, v8, v34
    v_readlane_b32 s64, v28, 0
    v_readlane_b32 s65, v29, 0
    v_readlane_b32 s66, v30, 0
    v_readlane_b32 s67, v28, 16
    v_readlane_b32 s68, v29, 16
    v_readlane_b32 s69, v30, 16
    v_readlane_b32 s70, v28, 32
    v_readlane_b32 s71, v29, 32
    v_readlane_b32 s72, v30, 32
    v_readlane_b32 s73, v28, 48
    v_readlane_b32 s74, v29, 48
    v_readlane_b32 s75, v30, 48
    v_and_b32 v76, 0xffff, v2
    v_lshl_or_b32 v76, v6, 16, v76
    v_lshrrev_b32 v79, 16, v2
    v_lshl_or_b32 v76, v79, 26, v76
    ds_write_b32 v21, v76 offset:0
    v_and_b32 v77, 0xffff, v3
    v_lshl_or_b32 v77, v7, 16, v77
    v_lshrrev_b32 v79, 16, v3
    v_lshl_or_b32 v77, v79, 26, v77
    ds_write_b32 v21, v77 offset:1024
    v_and_b32 v78, 0xffff, v4
    v_lshl_or_b32 v78, v8, 16, v78
    v_lshrrev_b32 v79, 16, v4
    v_lshl_or_b32 v78, v79, 26, v78
    ds_write_b32 v21, v78 offset:2048
    s_mov_b32 s89, 0
    s_cmp_gt_u32 s64, 1024
    s_cselect_b32 s89, 1, s89
    s_cmp_gt_u32 s65, 1024
    s_cselect_b32 s89, 1, s89
    s_cmp_gt_u32 s66, 1024
    s_cselect_b32 s89, 1, s89
    s_cmp_gt_u32 s67, 1024
    s_cselect_b32 s89, 1, s89
    s_cmp_gt_u32 s68, 1024
    s_cselect_b32 s89, 1, s89
    s_cmp_gt_u32 s69, 1024
    s_cselect_b32 s89, 1, s89
    s_cmp_gt_u32 s70, 1024
    s_cselect_b32 s89, 1, s89
    s_cmp_gt_u32 s71, 1024
    s_cselect_b32 s89, 1, s89
    s_cmp_gt_u32 s72, 1024
    s_cselect_b32 s89, 1, s89
    s_cmp_gt_u32 s73, 1024
    s_cselect_b32 s89, 1, s89
    s_cmp_gt_u32 s74, 1024
    s_cselect_b32 s89, 1, s89
    s_cmp_gt_u32 s75, 1024
    s_cselect_b32 s89, 1, s89
    s_lshr_b32 s90, s84, 2
    s_cmp_lg_u32 s90, 3
    s_cbranch_scc1 k2_prio_26
    s_setprio 1
k2_prio_26:
    s_cmp_ge_u32 s84, 5
    s_cbranch_scc1 k2_lp_27
    s_mul_i32 s91, s86, 53760
    s_add_u32 s92, s91, 49152
    buffer_load_dwordx4 v[118:121], v1, s[20:23], s92 offen
k2_lp_27:
    s_mul_i32 s91, s86, 53760
    s_add_u32 s92, s91, 231424
    buffer_load_dwordx4 v[64:67], v1, s[20:23], s92 offen
k2_lp_28:
    s_waitcnt lgkmcnt(0)
    s_barrier
    ds_read_b32 v86, v84 offset:12
    ds_read_b32 v18, v17 offset:0
    ds_read_b32 v87, v17 offset:1024
    s_waitcnt lgkmcnt(0)
    v_readfirstlane_b32 s90, v86
    s_nop 3
    s_or_b32 s89, s89, s90
    s_cmp_lg_u32 s89, 0
    s_cbranch_scc1 k2_pm1
    s_mul_i32 s91, s86, 53760
    s_add_u32 s92, s91, 247808
    buffer_load_dwordx4 v[68:71], v1, s[20:23], s92 offen
k2_lp_29:
    s_cmp_ge_u32 s84, 5
    s_cbranch_scc1 k2_lp_30
    s_mul_i32 s91, s86, 53760
    s_add_u32 s92, s91, 264192
    buffer_load_dwordx4 v[72:75], v1, s[20:23], s92 offen
k2_lp_30:
    v_and_b32 v94, 0xffff, v18
    v_lshrrev_b32 v96, 26, v18
    v_bfe_u32 v95, v18, 16, 10
    v_sub_u32 v96, v96, v16
    v_add_lshl_u32 v95, v95, v15, 2
    v_lshl_add_u32 v94, v94, 2, v14
    v_add_u32 v95, 134272, v95
k2_map_31:
    v_cmpx_lt_i32 vcc, 0, v96
    s_cbranch_execz k2_mapd_32
    v_min_u32 v93, 4, v96
    v_add3_u32 v93, v93, v94, -1
    ds_write_b32 v95, v93
    v_add_u32 v94, 64, v94
    v_add_u32 v95, 16, v95
    v_add_u32 v96, -16, v96
    s_branch k2_map_31
k2_mapd_32:
    s_mov_b64 exec, -1
    v_mov_b32 v18, v87
k2_pm1:
    s_waitcnt lgkmcnt(0)
    s_barrier
    s_cmp_lg_u32 s84, 15
    s_cbranch_scc1 k2_nosc
    s_cmp_eq_u32 s89, 0
    s_cbranch_scc1 k2_sc1
    s_waitcnt vmcnt(0)
k2_sc1:
    s_waitcnt vmcnt(0)
    v_max3_u32 v84, v36, v37, v38
    v_max3_u32 v84, v84, v39, v40
    v_max3_u32 v84, v84, v41, v42
    v_max3_u32 v84, v84, v43, v44
    v_max3_u32 v84, v84, v45, v46
    v_max3_u32 v84, v84, v47, v48
    v_max3_u32 v84, v84, v49, v50
    v_max_u32 v84, v84, v51
    v_add_u32 v36, -1, v36
    v_add_u32 v37, -1, v37
    v_add_u32 v38, -1, v38
    v_add_u32 v39, -1, v39
    v_add_u32 v40, -1, v40
    v_add_u32 v41, -1, v41
    v_add_u32 v42, -1, v42
    v_add_u32 v43, -1, v43
    v_add_u32 v44, -1, v44
    v_add_u32 v45, -1, v45
    v_add_u32 v46, -1, v46
    v_add_u32 v47, -1, v47
    v_add_u32 v48, -1, v48
    v_add_u32 v49, -1, v49
    v_add_u32 v50, -1, v50
    v_add_u32 v51, -1, v51
    v_min3_u32 v85, v36, v37, v38
    v_min3_u32 v85, v85, v39, v40
    v_min3_u32 v85, v85, v41, v42
    v_min3_u32 v85, v85, v43, v44
    v_min3_u32 v85, v85, v45, v46
    v_min3_u32 v85, v85, v47, v48
    v_min3_u32 v85, v85, v49, v50
    v_min_u32 v85, v85, v51
    s_nop 1
    v_max_u32_dpp v84, v84, v84 row_shr:1 row_mask:0xf bank_mask:0xf
    v_min_u32_dpp v85, v85, v85 row_shr:1 row_mask:0xf bank_mask:0xf
    s_nop 1
    v_max_u32_dpp v84, v84, v84 row_shr:2 row_mask:0xf bank_mask:0xf
    v_min_u32_dpp v85, v85, v85 row_shr:2 row_mask:0xf bank_mask:0xf
    s_nop 1
    v_max_u32_dpp v84, v84, v84 row_shr:4 row_mask:0xf bank_mask:0xf
    v_min_u32_dpp v85, v85, v85 row_shr:4 row_mask:0xf bank_mask:0xf
    s_nop 1
    v_max_u32_dpp v84, v84, v84 row_shr:8 row_mask:0xf bank_mask:0xf
    v_min_u32_dpp v85, v85, v85 row_shr:8 row_mask:0xf bank_mask:0xf
    s_nop 1
    v_max_u32_dpp v84, v84, v84 row_bcast:15 row_mask:0xa bank_mask:0xf
    v_min_u32_dpp v85, v85, v85 row_bcast:15 row_mask:0xa bank_mask:0xf
    s_nop 1
    v_max_u32_dpp v84, v84, v84 row_bcast:31 row_mask:0xc bank_mask:0xf
    v_min_u32_dpp v85, v85, v85 row_bcast:31 row_mask:0xc bank_mask:0xf
    s_nop 1
    v_readlane_b32 s90, v84, 63
    v_readlane_b32 s91, v85, 63
    s_nop 3
    s_lshr_b32 s92, s90, 7
    s_add_u32 s94, s91, 1
    s_lshr_b32 s94, s94, 7
    s_cmp_eq_u32 s90, 0
    s_cselect_b32 s92, 127, s92
    s_cselect_b32 s94, 127, s94
    s_mov_b32 s95, 0
    s_cmp_ge_u32 s92, 255
    s_cselect_b32 s95, 1, s95
    s_cmp_lt_u32 s92, 22
    s_cselect_b32 s95, 1, s95
    s_add_u32 s94, s94, 8
    s_cmp_lt_u32 s94, s92
    s_cselect_b32 s95, 1, s95
    s_sub_u32 s82, 275, s92
    s_lshl_b32 s82, s82, 23
    s_sub_u32 s83, s92, 21
    s_lshl_b32 s83, s83, 23
    v_mov_b32 v84, 155792
    v_mov_b32 v86, s82
    v_mov_b32 v87, s83
    v_mov_b32 v88, s95
    ds_write_b64 v84, v[86:87]
    ds_write_b32 v84, v88 offset:8
k2_nosc:
    s_cmp_lg_u32 s89, 0
    s_cbranch_scc1 k2_pm2
    v_cmp_gt_u32 s[40:41], s64, v0
    v_add_u32 v91, 134272, v102
    ds_read_b32 v34, v91
    s_waitcnt lgkmcnt(0)
    s_mov_b64 s[42:43], 0
    s_mov_b64 s[44:45], 0
    s_mov_b64 s[46:47], 0
    s_mov_b64 exec, s[40:41]
    s_cbranch_execz k2_lr_33
    v_and_b32 v35, -4, v34
    buffer_load_dwordx4 v[28:31], v35, s[24:27], 0 offen
    v_lshrrev_b32 v35, 1, v35
    buffer_load_dwordx2 v[32:33], v35, s[76:79], 0 offen
    v_and_b32 v34, 3, v34
    v_cmp_le_u32 s[42:43], 1, v34
    v_cmp_le_u32 s[44:45], 2, v34
    v_cmp_le_u32 s[46:47], 3, v34
k2_lr_33:
    s_mov_b64 exec, -1
    s_cmp_eq_u64 s[40:41], 0
    s_cbranch_scc1 k2_wf0_34
    s_waitcnt vmcnt(2)
    s_branch k2_wf0_35
k2_wf0_34:
    s_waitcnt vmcnt(0)
k2_wf0_35:
    ds_write_b128 v13, v[106:109] offset:0
    ds_write_b128 v13, v[110:113] offset:16384
    ds_write_b128 v13, v[114:117] offset:32768
    s_cmp_ge_u32 s84, 5
    s_cbranch_scc1 k2_wf_36
    ds_write_b128 v13, v[118:121] offset:49152
k2_wf_36:
    v_and_b32 v94, 0xffff, v18
    v_lshrrev_b32 v96, 26, v18
    v_bfe_u32 v95, v18, 16, 10
    v_sub_u32 v96, v96, v16
    v_add_lshl_u32 v95, v95, v15, 2
    v_lshl_add_u32 v94, v94, 2, v14
    v_add_u32 v95, 138368, v95
k2_map_37:
    v_cmpx_lt_i32 vcc, 0, v96
    s_cbranch_execz k2_mapd_38
    v_min_u32 v93, 4, v96
    v_add3_u32 v93, v93, v94, -1
    ds_write_b32 v95, v93
    v_add_u32 v94, 64, v94
    v_add_u32 v95, 16, v95
    v_add_u32 v96, -16, v96
    s_branch k2_map_37
k2_mapd_38:
    s_mov_b64 exec, -1
    ds_read_b32 v18, v17 offset:2048
k2_pm2:
    s_waitcnt lgkmcnt(0)
    s_barrier
    s_cmp_lg_u32 s89, 0
    s_cbranch_scc1 k2_pm3
    v_cmp_gt_u32 s[48:49], s65, v0
    v_add_u32 v91, 138368, v102
    ds_read_b32 v42, v91
    s_mul_i32 s14, s87, 5000
    s_mul_i32 s15, s86, 1250
    s_add_u32 s14, s14, s15
    s_lshl_b32 s15, s14, 1
    s_add_u32 s60, s8, s15
    s_addc_u32 s61, s9, 0
    s_and_b32 s61, s61, 0xffff
    s_mov_b32 s62, 2500
    s_mov_b32 s63, 0x20000
    v_add_u32 v81, 0, v0
    v_lshlrev_b32 v81, 1, v81
    buffer_load_ushort v5, v81, s[60:63], 0 offen
    v_add_u32 v81, 1024, v0
    v_lshlrev_b32 v81, 1, v81
    buffer_load_ushort v9, v81, s[60:63], 0 offen
    v_and_b32 v94, 0xffff, v18
    v_lshrrev_b32 v96, 26, v18
    v_bfe_u32 v95, v18, 16, 10
    v_sub_u32 v96, v96, v16
    v_add_lshl_u32 v95, v95, v15, 2
    v_lshl_add_u32 v94, v94, 2, v14
    v_add_u32 v95, 134272, v95
k2_map_39:
    v_cmpx_lt_i32 vcc, 0, v96
    s_cbranch_execz k2_mapd_40
    v_min_u32 v93, 4, v96
    v_add3_u32 v93, v93, v94, -1
    ds_write_b32 v95, v93
    v_add_u32 v94, 64, v94
    v_add_u32 v95, 16, v95
    v_add_u32 v96, -16, v96
    s_branch k2_map_39
k2_mapd_40:
    s_mov_b64 exec, -1
    ds_read_b32 v18, v17 offset:3072
k2_pm3:
    s_waitcnt lgkmcnt(0)
    s_cmp_lg_u32 s89, 0
    s_cbranch_scc1 k2_slowb
    s_waitcnt vmcnt(2)
    s_barrier
    v_mov_b32 v88, 155792
    ds_read_b96 v[84:86], v88
    v_mad_u32_u16 v76, v28, 1, v101
    v_mad_u32_u16 v77, v29, 1, v101
    v_mad_u32_u16 v78, v30, 1, v101
    v_mad_u32_u16 v79, v31, 1, v101
    s_mov_b64 exec, s[40:41]
    ds_read_b64 v[52:53], v76
    s_mov_b64 exec, s[42:43]
    ds_read_b64 v[54:55], v77
    s_mov_b64 exec, s[44:45]
    ds_read_b64 v[56:57], v78
    s_mov_b64 exec, s[46:47]
    ds_read_b64 v[58:59], v79
    s_mov_b64 exec, -1
    s_waitcnt lgkmcnt(0)
    v_mov_b32 v104, v84
    v_readfirstlane_b32 s83, v85
    v_readfirstlane_b32 s95, v86
    s_barrier
    s_cmp_lg_u32 s95, 0
    s_cbranch_scc1 k2_slow
    s_mov_b64 s[50:51], 0
    s_mov_b64 s[52:53], 0
    s_mov_b64 s[54:55], 0
    s_mov_b64 exec, s[48:49]
    s_cbranch_execz k2_lr_43
    v_and_b32 v43, -4, v42
    buffer_load_dwordx4 v[36:39], v43, s[24:27], 0 offen
    v_lshrrev_b32 v43, 1, v43
    buffer_load_dwordx2 v[40:41], v43, s[76:79], 0 offen
    v_and_b32 v42, 3, v42
    v_cmp_le_u32 s[50:51], 1, v42
    v_cmp_le_u32 s[52:53], 2, v42
    v_cmp_le_u32 s[54:55], 3, v42
k2_lr_43:
    s_mov_b64 exec, -1
    ds_write_b128 v13, v[60:63] offset:0
    ds_write_b128 v13, v[64:67] offset:16384
    ds_write_b128 v13, v[68:71] offset:32768
    s_cmp_ge_u32 s84, 5
    s_cbranch_scc1 k2_wf_44
    ds_write_b128 v13, v[72:75] offset:49152
k2_wf_44:
    s_mul_i32 s91, s86, 53760
    s_add_u32 s92, s91, 430080
    buffer_load_dwordx4 v[106:109], v1, s[20:23], s92 offen
    s_add_u32 s92, s91, 446464
    buffer_load_dwordx4 v[110:113], v1, s[20:23], s92 offen
    s_add_u32 s92, s91, 462848
    buffer_load_dwordx4 v[114:117], v1, s[20:23], s92 offen
    s_cmp_ge_u32 s84, 5
    s_cbranch_scc1 k2_lf_45
    s_add_u32 s92, s91, 479232
    buffer_load_dwordx4 v[118:121], v1, s[20:23], s92 offen
k2_lf_45:
    v_cmp_gt_u32 s[56:57], s66, v0
    v_add_u32 v91, 134272, v102
    ds_read_b32 v50, v91
    v_and_b32 v94, 0xffff, v18
    v_lshrrev_b32 v96, 26, v18
    v_bfe_u32 v95, v18, 16, 10
    v_sub_u32 v96, v96, v16
    v_add_lshl_u32 v95, v95, v15, 2
    v_lshl_add_u32 v94, v94, 2, v14
    v_add_u32 v95, 138368, v95
k2_map_46:
    v_cmpx_lt_i32 vcc, 0, v96
    s_cbranch_execz k2_mapd_47
    v_min_u32 v93, 4, v96
    v_add3_u32 v93, v93, v94, -1
    ds_write_b32 v95, v93
    v_add_u32 v94, 64, v94
    v_add_u32 v95, 16, v95
    v_add_u32 v96, -16, v96
    s_branch k2_map_46
k2_mapd_47:
    s_mov_b64 exec, -1
    ds_read_b32 v18, v17 offset:4096
    v_lshlrev_b32 v80, 16, v32
    v_mul_f32 v80, v104, v80
    v_lshlrev_b32 v60, 16, v52
    v_and_b32 v61, v103, v52
    v_lshlrev_b32 v62, 16, v53
    v_and_b32 v63, v103, v53
    v_fma_f32 v60, v60, v80, v105
    v_fma_f32 v61, v61, v80, v105
    v_fma_f32 v62, v62, v80, v105
    v_fma_f32 v63, v63, v80, v105
    v_sub_u32 v60, v60, v105
    v_sub_u32 v61, v61, v105
    v_sub_u32 v62, v62, v105
    v_sub_u32 v63, v63, v105
    v_lshrrev_b32 v84, 16, v28
    v_and_b32 v81, v103, v32
    v_mul_f32 v81, v104, v81
    v_lshlrev_b32 v64, 16, v54
    v_and_b32 v65, v103, v54
    v_lshlrev_b32 v66, 16, v55
    v_and_b32 v67, v103, v55
    v_fma_f32 v64, v64, v81, v105
    v_fma_f32 v65, v65, v81, v105
    v_fma_f32 v66, v66, v81, v105
    v_fma_f32 v67, v67, v81, v105
    v_sub_u32 v64, v64, v105
    v_sub_u32 v65, v65, v105
    v_sub_u32 v66, v66, v105
    v_sub_u32 v67, v67, v105
    v_lshrrev_b32 v85, 16, v29
    s_waitcnt lgkmcnt(0)
    s_mov_b64 s[58:59], 0
    s_mov_b64 s[60:61], 0
    s_mov_b64 s[62:63], 0
    s_mov_b64 exec, s[56:57]
    s_cbranch_execz k2_lr_48
    v_and_b32 v51, -4, v50
    buffer_load_dwordx4 v[44:47], v51, s[24:27], 0 offen
    v_lshrrev_b32 v51, 1, v51
    buffer_load_dwordx2 v[48:49], v51, s[76:79], 0 offen
    v_and_b32 v50, 3, v50
    v_cmp_le_u32 s[58:59], 1, v50
    v_cmp_le_u32 s[60:61], 2, v50
    v_cmp_le_u32 s[62:63], 3, v50
k2_lr_48:
    s_mov_b64 exec, -1
    s_mov_b64 exec, s[40:41]
    ds_add_rtn_u64 v[60:61], v84, v[60:61]
    ds_add_rtn_u64 v[62:63], v84, v[62:63] offset:40000
    s_mov_b64 exec, -1
    s_mov_b64 exec, s[42:43]
    ds_add_rtn_u64 v[64:65], v85, v[64:65]
    ds_add_rtn_u64 v[66:67], v85, v[66:67] offset:40000
    s_mov_b64 exec, -1
    v_lshlrev_b32 v82, 16, v33
    v_mul_f32 v82, v104, v82
    v_lshlrev_b32 v68, 16, v56
    v_and_b32 v69, v103, v56
    v_lshlrev_b32 v70, 16, v57
    v_and_b32 v71, v103, v57
    v_fma_f32 v68, v68, v82, v105
    v_fma_f32 v69, v69, v82, v105
    v_fma_f32 v70, v70, v82, v105
    v_fma_f32 v71, v71, v82, v105
    v_sub_u32 v68, v68, v105
    v_sub_u32 v69, v69, v105
    v_sub_u32 v70, v70, v105
    v_sub_u32 v71, v71, v105
    v_lshrrev_b32 v86, 16, v30
    s_mov_b64 exec, s[44:45]
    ds_add_rtn_u64 v[68:69], v86, v[68:69]
    ds_add_rtn_u64 v[70:71], v86, v[70:71] offset:40000
    s_mov_b64 exec, -1
    v_and_b32 v83, v103, v33
    v_mul_f32 v83, v104, v83
    v_lshlrev_b32 v72, 16, v58
    v_and_b32 v73, v103, v58
    v_lshlrev_b32 v74, 16, v59
    v_and_b32 v75, v103, v59
    v_fma_f32 v72, v72, v83, v105
    v_fma_f32 v73, v73, v83, v105
    v_fma_f32 v74, v74, v83, v105
    v_fma_f32 v75, v75, v83, v105
    v_sub_u32 v72, v72, v105
    v_sub_u32 v73, v73, v105
    v_sub_u32 v74, v74, v105
    v_sub_u32 v75, v75, v105
    v_lshrrev_b32 v87, 16, v31
    s_mov_b64 exec, s[46:47]
    ds_add_rtn_u64 v[72:73], v87, v[72:73]
    ds_add_rtn_u64 v[74:75], v87, v[74:75] offset:40000
    s_mov_b64 exec, -1
    s_cmp_eq_u64 s[56:57], 0
    s_cbranch_scc1 k2_tw_49
    s_waitcnt vmcnt(2)
    s_branch k2_tw_50
k2_tw_49:
    s_waitcnt vmcnt(0)
k2_tw_50:
    s_barrier
    v_mad_u32_u16 v76, v36, 1, v101
    v_mad_u32_u16 v77, v37, 1, v101
    v_mad_u32_u16 v78, v38, 1, v101
    v_mad_u32_u16 v79, v39, 1, v101
    s_mov_b64 exec, s[48:49]
    ds_read_b64 v[52:53], v76
    s_mov_b64 exec, s[50:51]
    ds_read_b64 v[54:55], v77
    s_mov_b64 exec, s[52:53]
    ds_read_b64 v[56:57], v78
    s_mov_b64 exec, s[54:55]
    ds_read_b64 v[58:59], v79
    s_mov_b64 exec, -1
    s_waitcnt lgkmcnt(0)
    s_barrier
    ds_write_b128 v13, v[106:109] offset:0
    ds_write_b128 v13, v[110:113] offset:16384
    ds_write_b128 v13, v[114:117] offset:32768
    s_cmp_ge_u32 s84, 5
    s_cbranch_scc1 k2_wf_51
    ds_write_b128 v13, v[118:121] offset:49152
k2_wf_51:
    s_mul_i32 s91, s86, 53760
    s_add_u32 s92, s91, 645120
    buffer_load_dwordx4 v[106:109], v1, s[20:23], s92 offen
    s_add_u32 s92, s91, 661504
    buffer_load_dwordx4 v[110:113], v1, s[20:23], s92 offen
    s_add_u32 s92, s91, 677888
    buffer_load_dwordx4 v[114:117], v1, s[20:23], s92 offen
    s_cmp_ge_u32 s84, 5
    s_cbranch_scc1 k2_lf_52
    s_add_u32 s92, s91, 694272
    buffer_load_dwordx4 v[118:121], v1, s[20:23], s92 offen
k2_lf_52:
    s_mov_b64 exec, s[40:41]
    v_or3_b32 v100, v100, v60, v61
    v_or3_b32 v100, v100, v62, v63
    s_mov_b64 exec, s[42:43]
    v_or3_b32 v100, v100, v64, v65
    v_or3_b32 v100, v100, v66, v67
    s_mov_b64 exec, s[44:45]
    v_or3_b32 v100, v100, v68, v69
    v_or3_b32 v100, v100, v70, v71
    s_mov_b64 exec, s[46:47]
    v_or3_b32 v100, v100, v72, v73
    v_or3_b32 v100, v100, v74, v75
    s_mov_b64 exec, -1
    v_cmp_gt_u32 s[40:41], s67, v0
    v_add_u32 v91, 138368, v102
    ds_read_b32 v34, v91
    v_and_b32 v94, 0xffff, v18
    v_lshrrev_b32 v96, 26, v18
    v_bfe_u32 v95, v18, 16, 10
    v_sub_u32 v96, v96, v16
    v_add_lshl_u32 v95, v95, v15, 2
    v_lshl_add_u32 v94, v94, 2, v14
    v_add_u32 v95, 134272, v95
k2_map_53:
    v_cmpx_lt_i32 vcc, 0, v96
    s_cbranch_execz k2_mapd_54
    v_min_u32 v93, 4, v96
    v_add3_u32 v93, v93, v94, -1
    ds_write_b32 v95, v93
    v_add_u32 v94, 64, v94
    v_add_u32 v95, 16, v95
    v_add_u32 v96, -16, v96
    s_branch k2_map_53
k2_mapd_54:
    s_mov_b64 exec, -1
    ds_read_b32 v18, v17 offset:5120
    v_lshlrev_b32 v80, 16, v40
    v_mul_f32 v80, v104, v80
    v_lshlrev_b32 v60, 16, v52
    v_and_b32 v61, v103, v52
    v_lshlrev_b32 v62, 16, v53
    v_and_b32 v63, v103, v53
    v_fma_f32 v60, v60, v80, v105
    v_fma_f32 v61, v61, v80, v105
    v_fma_f32 v62, v62, v80, v105
    v_fma_f32 v63, v63, v80, v105
    v_sub_u32 v60, v60, v105
    v_sub_u32 v61, v61, v105
    v_sub_u32 v62, v62, v105
    v_sub_u32 v63, v63, v105
    v_lshrrev_b32 v84, 16, v36
    v_and_b32 v81, v103, v40
    v_mul_f32 v81, v104, v81
    v_lshlrev_b32 v64, 16, v54
    v_and_b32 v65, v103, v54
    v_lshlrev_b32 v66, 16, v55
    v_and_b32 v67, v103, v55
    v_fma_f32 v64, v64, v81, v105
    v_fma_f32 v65, v65, v81, v105
    v_fma_f32 v66, v66, v81, v105
    v_fma_f32 v67, v67, v81, v105
    v_sub_u32 v64, v64, v105
    v_sub_u32 v65, v65, v105
    v_sub_u32 v66, v66, v105
    v_sub_u32 v67, v67, v105
    v_lshrrev_b32 v85, 16, v37
    s_waitcnt lgkmcnt(0)
    s_mov_b64 s[42:43], 0
    s_mov_b64 s[44:45], 0
    s_mov_b64 s[46:47], 0
    s_mov_b64 exec, s[40:41]
    s_cbranch_execz k2_lr_55
    v_and_b32 v35, -4, v34
    buffer_load_dwordx4 v[28:31], v35, s[24:27], 0 offen
    v_lshrrev_b32 v35, 1, v35
    buffer_load_dwordx2 v[32:33], v35, s[76:79], 0 offen
    v_and_b32 v34, 3, v34
    v_cmp_le_u32 s[42:43], 1, v34
    v_cmp_le_u32 s[44:45], 2, v34
    v_cmp_le_u32 s[46:47], 3, v34
k2_lr_55:
    s_mov_b64 exec, -1
    s_mov_b64 exec, s[48:49]
    ds_add_rtn_u64 v[60:61], v84, v[60:61]
    ds_add_rtn_u64 v[62:63], v84, v[62:63] offset:40000
    s_mov_b64 exec, -1
    s_mov_b64 exec, s[50:51]
    ds_add_rtn_u64 v[64:65], v85, v[64:65]
    ds_add_rtn_u64 v[66:67], v85, v[66:67] offset:40000
    s_mov_b64 exec, -1
    v_lshlrev_b32 v82, 16, v41
    v_mul_f32 v82, v104, v82
    v_lshlrev_b32 v68, 16, v56
    v_and_b32 v69, v103, v56
    v_lshlrev_b32 v70, 16, v57
    v_and_b32 v71, v103, v57
    v_fma_f32 v68, v68, v82, v105
    v_fma_f32 v69, v69, v82, v105
    v_fma_f32 v70, v70, v82, v105
    v_fma_f32 v71, v71, v82, v105
    v_sub_u32 v68, v68, v105
    v_sub_u32 v69, v69, v105
    v_sub_u32 v70, v70, v105
    v_sub_u32 v71, v71, v105
    v_lshrrev_b32 v86, 16, v38
    s_mov_b64 exec, s[52:53]
    ds_add_rtn_u64 v[68:69], v86, v[68:69]
    ds_add_rtn_u64 v[70:71], v86, v[70:71] offset:40000
    s_mov_b64 exec, -1
    v_and_b32 v83, v103, v41
    v_mul_f32 v83, v104, v83
    v_lshlrev_b32 v72, 16, v58
    v_and_b32 v73, v103, v58
    v_lshlrev_b32 v74, 16, v59
    v_and_b32 v75, v103, v59
    v_fma_f32 v72, v72, v83, v105
    v_fma_f32 v73, v73, v83, v105
    v_fma_f32 v74, v74, v83, v105
    v_fma_f32 v75, v75, v83, v105
    v_sub_u32 v72, v72, v105
    v_sub_u32 v73, v73, v105
    v_sub_u32 v74, v74, v105
    v_sub_u32 v75, v75, v105
    v_lshrrev_b32 v87, 16, v39
    s_mov_b64 exec, s[54:55]
    ds_add_rtn_u64 v[72:73], v87, v[72:73]
    ds_add_rtn_u64 v[74:75], v87, v[74:75] offset:40000
    s_mov_b64 exec, -1
    s_cmp_eq_u64 s[40:41], 0
    s_cbranch_scc1 k2_tw_56
    s_waitcnt vmcnt(2)
    s_branch k2_tw_57
k2_tw_56:
    s_waitcnt vmcnt(0)
k2_tw_57:
    s_barrier
    v_mad_u32_u16 v76, v44, 1, v101
    v_mad_u32_u16 v77, v45, 1, v101
    v_mad_u32_u16 v78, v46, 1, v101
    v_mad_u32_u16 v79, v47, 1, v101
    s_mov_b64 exec, s[56:57]
    ds_read_b64 v[52:53], v76
    s_mov_b64 exec, s[58:59]
    ds_read_b64 v[54:55], v77
    s_mov_b64 exec, s[60:61]
    ds_read_b64 v[56:57], v78
    s_mov_b64 exec, s[62:63]
    ds_read_b64 v[58:59], v79
    s_mov_b64 exec, -1
    s_waitcnt lgkmcnt(0)
    s_barrier
    ds_write_b128 v13, v[106:109] offset:0
    ds_write_b128 v13, v[110:113] offset:16384
    ds_write_b128 v13, v[114:117] offset:32768
    s_cmp_ge_u32 s84, 5
    s_cbranch_scc1 k2_wf_58
    ds_write_b128 v13, v[118:121] offset:49152
k2_wf_58:
    s_mul_i32 s91, s86, 53760
    s_add_u32 s92, s91, 860160
    buffer_load_dwordx4 v[106:109], v1, s[20:23], s92 offen
    s_add_u32 s92, s91, 876544
    buffer_load_dwordx4 v[110:113], v1, s[20:23], s92 offen
    s_add_u32 s92, s91, 892928
    buffer_load_dwordx4 v[114:117], v1, s[20:23], s92 offen
    s_cmp_ge_u32 s84, 5
    s_cbranch_scc1 k2_lf_59
    s_add_u32 s92, s91, 909312
    buffer_load_dwordx4 v[118:121], v1, s[20:23], s92 offen
k2_lf_59:
    s_mov_b64 exec, s[48:49]
    v_or3_b32 v100, v100, v60, v61
    v_or3_b32 v100, v100, v62, v63
    s_mov_b64 exec, s[50:51]
    v_or3_b32 v100, v100, v64, v65
    v_or3_b32 v100, v100, v66, v67
    s_mov_b64 exec, s[52:53]
    v_or3_b32 v100, v100, v68, v69
    v_or3_b32 v100, v100, v70, v71
    s_mov_b64 exec, s[54:55]
    v_or3_b32 v100, v100, v72, v73
    v_or3_b32 v100, v100, v74, v75
    s_mov_b64 exec, -1
    v_cmp_gt_u32 s[48:49], s68, v0
    v_add_u32 v91, 134272, v102
    ds_read_b32 v42, v91
    v_and_b32 v94, 0xffff, v18
    v_lshrrev_b32 v96, 26, v18
    v_bfe_u32 v95, v18, 16, 10
    v_sub_u32 v96, v96, v16
    v_add_lshl_u32 v95, v95, v15, 2
    v_lshl_add_u32 v94, v94, 2, v14
    v_add_u32 v95, 138368, v95
k2_map_60:
    v_cmpx_lt_i32 vcc, 0, v96
    s_cbranch_execz k2_mapd_61
    v_min_u32 v93, 4, v96
    v_add3_u32 v93, v93, v94, -1
    ds_write_b32 v95, v93
    v_add_u32 v94, 64, v94
    v_add_u32 v95, 16, v95
    v_add_u32 v96, -16, v96
    s_branch k2_map_60
k2_mapd_61:
    s_mov_b64 exec, -1
    ds_read_b32 v18, v17 offset:6144
    v_lshlrev_b32 v80, 16, v48
    v_mul_f32 v80, v104, v80
    v_lshlrev_b32 v60, 16, v52
    v_and_b32 v61, v103, v52
    v_lshlrev_b32 v62, 16, v53
    v_and_b32 v63, v103, v53
    v_fma_f32 v60, v60, v80, v105
    v_fma_f32 v61, v61, v80, v105
    v_fma_f32 v62, v62, v80, v105
    v_fma_f32 v63, v63, v80, v105
    v_sub_u32 v60, v60, v105
    v_sub_u32 v61, v61, v105
    v_sub_u32 v62, v62, v105
    v_sub_u32 v63, v63, v105
    v_lshrrev_b32 v84, 16, v44
    v_and_b32 v81, v103, v48
    v_mul_f32 v81, v104, v81
    v_lshlrev_b32 v64, 16, v54
    v_and_b32 v65, v103, v54
    v_lshlrev_b32 v66, 16, v55
    v_and_b32 v67, v103, v55
    v_fma_f32 v64, v64, v81, v105
    v_fma_f32 v65, v65, v81, v105
    v_fma_f32 v66, v66, v81, v105
    v_fma_f32 v67, v67, v81, v105
    v_sub_u32 v64, v64, v105
    v_sub_u32 v65, v65, v105
    v_sub_u32 v66, v66, v105
    v_sub_u32 v67, v67, v105
    v_lshrrev_b32 v85, 16, v45
    s_waitcnt lgkmcnt(0)
    s_mov_b64 s[50:51], 0
    s_mov_b64 s[52:53], 0
    s_mov_b64 s[54:55], 0
    s_mov_b64 exec, s[48:49]
    s_cbranch_execz k2_lr_62
    v_and_b32 v43, -4, v42
    buffer_load_dwordx4 v[36:39], v43, s[24:27], 0 offen
    v_lshrrev_b32 v43, 1, v43
    buffer_load_dwordx2 v[40:41], v43, s[76:79], 0 offen
    v_and_b32 v42, 3, v42
    v_cmp_le_u32 s[50:51], 1, v42
    v_cmp_le_u32 s[52:53], 2, v42
    v_cmp_le_u32 s[54:55], 3, v42
k2_lr_62:
    s_mov_b64 exec, -1
    s_mov_b64 exec, s[56:57]
    ds_add_rtn_u64 v[60:61], v84, v[60:61]
    ds_add_rtn_u64 v[62:63], v84, v[62:63] offset:40000
    s_mov_b64 exec, -1
    s_mov_b64 exec, s[58:59]
    ds_add_rtn_u64 v[64:65], v85, v[64:65]
    ds_add_rtn_u64 v[66:67], v85, v[66:67] offset:40000
    s_mov_b64 exec, -1
    v_lshlrev_b32 v82, 16, v49
    v_mul_f32 v82, v104, v82
    v_lshlrev_b32 v68, 16, v56
    v_and_b32 v69, v103, v56
    v_lshlrev_b32 v70, 16, v57
    v_and_b32 v71, v103, v57
    v_fma_f32 v68, v68, v82, v105
    v_fma_f32 v69, v69, v82, v105
    v_fma_f32 v70, v70, v82, v105
    v_fma_f32 v71, v71, v82, v105
    v_sub_u32 v68, v68, v105
    v_sub_u32 v69, v69, v105
    v_sub_u32 v70, v70, v105
    v_sub_u32 v71, v71, v105
    v_lshrrev_b32 v86, 16, v46
    s_mov_b64 exec, s[60:61]
    ds_add_rtn_u64 v[68:69], v86, v[68:69]
    ds_add_rtn_u64 v[70:71], v86, v[70:71] offset:40000
    s_mov_b64 exec, -1
    v_and_b32 v83, v103, v49
    v_mul_f32 v83, v104, v83
    v_lshlrev_b32 v72, 16, v58
    v_and_b32 v73, v103, v58
    v_lshlrev_b32 v74, 16, v59
    v_and_b32 v75, v103, v59
    v_fma_f32 v72, v72, v83, v105
    v_fma_f32 v73, v73, v83, v105
    v_fma_f32 v74, v74, v83, v105
    v_fma_f32 v75, v75, v83, v105
    v_sub_u32 v72, v72, v105
    v_sub_u32 v73, v73, v105
    v_sub_u32 v74, v74, v105
    v_sub_u32 v75, v75, v105
    v_lshrrev_b32 v87, 16, v47
    s_mov_b64 exec, s[62:63]
    ds_add_rtn_u64 v[72:73], v87, v[72:73]
    ds_add_rtn_u64 v[74:75], v87, v[74:75] offset:40000
    s_mov_b64 exec, -1
    s_cmp_eq_u64 s[48:49], 0
    s_cbranch_scc1 k2_tw_63
    s_waitcnt vmcnt(2)
    s_branch k2_tw_64
k2_tw_63:
    s_waitcnt vmcnt(0)
k2_tw_64:
    s_barrier
    v_mad_u32_u16 v76, v28, 1, v101
    v_mad_u32_u16 v77, v29, 1, v101
    v_mad_u32_u16 v78, v30, 1, v101
    v_mad_u32_u16 v79, v31, 1, v101
    s_mov_b64 exec, s[40:41]
    ds_read_b64 v[52:53], v76
    s_mov_b64 exec, s[42:43]
    ds_read_b64 v[54:55], v77
    s_mov_b64 exec, s[44:45]
    ds_read_b64 v[56:57], v78
    s_mov_b64 exec, s[46:47]
    ds_read_b64 v[58:59], v79
    s_mov_b64 exec, -1
    s_waitcnt lgkmcnt(0)
    s_barrier
    ds_write_b128 v13, v[106:109] offset:0
    ds_write_b128 v13, v[110:113] offset:16384
    ds_write_b128 v13, v[114:117] offset:32768
    s_cmp_ge_u32 s84, 5
    s_cbranch_scc1 k2_wf_65
    ds_write_b128 v13, v[118:121] offset:49152
k2_wf_65:
    s_mul_i32 s91, s86, 53760
    s_add_u32 s92, s91, 1075200
    buffer_load_dwordx4 v[106:109], v1, s[20:23], s92 offen
    s_add_u32 s92, s91, 1091584
    buffer_load_dwordx4 v[110:113], v1, s[20:23], s92 offen
    s_add_u32 s92, s91, 1107968
    buffer_load_dwordx4 v[114:117], v1, s[20:23], s92 offen
    s_cmp_ge_u32 s84, 5
    s_cbranch_scc1 k2_lf_66
    s_add_u32 s92, s91, 1124352
    buffer_load_dwordx4 v[118:121], v1, s[20:23], s92 offen
k2_lf_66:
    s_mov_b64 exec, s[56:57]
    v_or3_b32 v100, v100, v60, v61
    v_or3_b32 v100, v100, v62, v63
    s_mov_b64 exec, s[58:59]
    v_or3_b32 v100, v100, v64, v65
    v_or3_b32 v100, v100, v66, v67
    s_mov_b64 exec, s[60:61]
    v_or3_b32 v100, v100, v68, v69
    v_or3_b32 v100, v100, v70, v71
    s_mov_b64 exec, s[62:63]
    v_or3_b32 v100, v100, v72, v73
    v_or3_b32 v100, v100, v74, v75
    s_mov_b64 exec, -1
    v_cmp_gt_u32 s[56:57], s69, v0
    v_add_u32 v91, 138368, v102
    ds_read_b32 v50, v91
    v_and_b32 v94, 0xffff, v18
    v_lshrrev_b32 v96, 26, v18
    v_bfe_u32 v95, v18, 16, 10
    v_sub_u32 v96, v96, v16
    v_add_lshl_u32 v95, v95, v15, 2
    v_lshl_add_u32 v94, v94, 2, v14
    v_add_u32 v95, 134272, v95
k2_map_67:
    v_cmpx_lt_i32 vcc, 0, v96
    s_cbranch_execz k2_mapd_68
    v_min_u32 v93, 4, v96
    v_add3_u32 v93, v93, v94, -1
    ds_write_b32 v95, v93
    v_add_u32 v94, 64, v94
    v_add_u32 v95, 16, v95
    v_add_u32 v96, -16, v96
    s_branch k2_map_67
k2_mapd_68:
    s_mov_b64 exec, -1
    ds_read_b32 v18, v17 offset:7168
    v_lshlrev_b32 v80, 16, v32
    v_mul_f32 v80, v104, v80
    v_lshlrev_b32 v60, 16, v52
    v_and_b32 v61, v103, v52
    v_lshlrev_b32 v62, 16, v53
    v_and_b32 v63, v103, v53
    v_fma_f32 v60, v60, v80, v105
    v_fma_f32 v61, v61, v80, v105
    v_fma_f32 v62, v62, v80, v105
    v_fma_f32 v63, v63, v80, v105
    v_sub_u32 v60, v60, v105
    v_sub_u32 v61, v61, v105
    v_sub_u32 v62, v62, v105
    v_sub_u32 v63, v63, v105
    v_lshrrev_b32 v84, 16, v28
    v_and_b32 v81, v103, v32
    v_mul_f32 v81, v104, v81
    v_lshlrev_b32 v64, 16, v54
    v_and_b32 v65, v103, v54
    v_lshlrev_b32 v66, 16, v55
    v_and_b32 v67, v103, v55
    v_fma_f32 v64, v64, v81, v105
    v_fma_f32 v65, v65, v81, v105
    v_fma_f32 v66, v66, v81, v105
    v_fma_f32 v67, v67, v81, v105
    v_sub_u32 v64, v64, v105
    v_sub_u32 v65, v65, v105
    v_sub_u32 v66, v66, v105
    v_sub_u32 v67, v67, v105
    v_lshrrev_b32 v85, 16, v29
    s_waitcnt lgkmcnt(0)
    s_mov_b64 s[58:59], 0
    s_mov_b64 s[60:61], 0
    s_mov_b64 s[62:63], 0
    s_mov_b64 exec, s[56:57]
    s_cbranch_execz k2_lr_69
    v_and_b32 v51, -4, v50
    buffer_load_dwordx4 v[44:47], v51, s[24:27], 0 offen
    v_lshrrev_b32 v51, 1, v51
    buffer_load_dwordx2 v[48:49], v51, s[76:79], 0 offen
    v_and_b32 v50, 3, v50
    v_cmp_le_u32 s[58:59], 1, v50
    v_cmp_le_u32 s[60:61], 2, v50
    v_cmp_le_u32 s[62:63], 3, v50
k2_lr_69:
    s_mov_b64 exec, -1
    s_mov_b64 exec, s[40:41]
    ds_add_rtn_u64 v[60:61], v84, v[60:61]
    ds_add_rtn_u64 v[62:63], v84, v[62:63] offset:40000
    s_mov_b64 exec, -1
    s_mov_b64 exec, s[42:43]
    ds_add_rtn_u64 v[64:65], v85, v[64:65]
    ds_add_rtn_u64 v[66:67], v85, v[66:67] offset:40000
    s_mov_b64 exec, -1
    v_lshlrev_b32 v82, 16, v33
    v_mul_f32 v82, v104, v82
    v_lshlrev_b32 v68, 16, v56
    v_and_b32 v69, v103, v56
    v_lshlrev_b32 v70, 16, v57
    v_and_b32 v71, v103, v57
    v_fma_f32 v68, v68, v82, v105
    v_fma_f32 v69, v69, v82, v105
    v_fma_f32 v70, v70, v82, v105
    v_fma_f32 v71, v71, v82, v105
    v_sub_u32 v68, v68, v105
    v_sub_u32 v69, v69, v105
    v_sub_u32 v70, v70, v105
    v_sub_u32 v71, v71, v105
    v_lshrrev_b32 v86, 16, v30
    s_mov_b64 exec, s[44:45]
    ds_add_rtn_u64 v[68:69], v86, v[68:69]
    ds_add_rtn_u64 v[70:71], v86, v[70:71] offset:40000
    s_mov_b64 exec, -1
    v_and_b32 v83, v103, v33
    v_mul_f32 v83, v104, v83
    v_lshlrev_b32 v72, 16, v58
    v_and_b32 v73, v103, v58
    v_lshlrev_b32 v74, 16, v59
    v_and_b32 v75, v103, v59
    v_fma_f32 v72, v72, v83, v105
    v_fma_f32 v73, v73, v83, v105
    v_fma_f32 v74, v74, v83, v105
    v_fma_f32 v75, v75, v83, v105
    v_sub_u32 v72, v72, v105
    v_sub_u32 v73, v73, v105
    v_sub_u32 v74, v74, v105
    v_sub_u32 v75, v75, v105
    v_lshrrev_b32 v87, 16, v31
    s_mov_b64 exec, s[46:47]
    ds_add_rtn_u64 v[72:73], v87, v[72:73]
    ds_add_rtn_u64 v[74:75], v87, v[74:75] offset:40000
    s_mov_b64 exec, -1
    s_cmp_eq_u64 s[56:57], 0
    s_cbranch_scc1 k2_tw_70
    s_waitcnt vmcnt(2)
    s_branch k2_tw_71
k2_tw_70:
    s_waitcnt vmcnt(0)
k2_tw_71:
    s_barrier
    v_mad_u32_u16 v76, v36, 1, v101
    v_mad_u32_u16 v77, v37, 1, v101
    v_mad_u32_u16 v78, v38, 1, v101
    v_mad_u32_u16 v79, v39, 1, v101
    s_mov_b64 exec, s[48:49]
    ds_read_b64 v[52:53], v76
    s_mov_b64 exec, s[50:51]
    ds_read_b64 v[54:55], v77
    s_mov_b64 exec, s[52:53]
    ds_read_b64 v[56:57], v78
    s_mov_b64 exec, s[54:55]
    ds_read_b64 v[58:59], v79
    s_mov_b64 exec, -1
    s_waitcnt lgkmcnt(0)
    s_barrier
    ds_write_b128 v13, v[106:109] offset:0
    ds_write_b128 v13, v[110:113] offset:16384
    ds_write_b128 v13, v[114:117] offset:32768
    s_cmp_ge_u32 s84, 5
    s_cbranch_scc1 k2_wf_72
    ds_write_b128 v13, v[118:121] offset:49152
k2_wf_72:
    s_mul_i32 s91, s86, 53760
    s_add_u32 s92, s91, 1290240
    buffer_load_dwordx4 v[106:109], v1, s[20:23], s92 offen
    s_add_u32 s92, s91, 1306624
    buffer_load_dwordx4 v[110:113], v1, s[20:23], s92 offen
    s_add_u32 s92, s91, 1323008
    buffer_load_dwordx4 v[114:117], v1, s[20:23], s92 offen
    s_cmp_ge_u32 s84, 5
    s_cbranch_scc1 k2_lf_73
    s_add_u32 s92, s91, 1339392
    buffer_load_dwordx4 v[118:121], v1, s[20:23], s92 offen
k2_lf_73:
    s_mov_b64 exec, s[40:41]
    v_or3_b32 v100, v100, v60, v61
    v_or3_b32 v100, v100, v62, v63
    s_mov_b64 exec, s[42:43]
    v_or3_b32 v100, v100, v64, v65
    v_or3_b32 v100, v100, v66, v67
    s_mov_b64 exec, s[44:45]
    v_or3_b32 v100, v100, v68, v69
    v_or3_b32 v100, v100, v70, v71
    s_mov_b64 exec, s[46:47]
    v_or3_b32 v100, v100, v72, v73
    v_or3_b32 v100, v100, v74, v75
    s_mov_b64 exec, -1
    v_cmp_gt_u32 s[40:41], s70, v0
    v_add_u32 v91, 134272, v102
    ds_read_b32 v34, v91
    v_and_b32 v94, 0xffff, v18
    v_lshrrev_b32 v96, 26, v18
    v_bfe_u32 v95, v18, 16, 10
    v_sub_u32 v96, v96, v16
    v_add_lshl_u32 v95, v95, v15, 2
    v_lshl_add_u32 v94, v94, 2, v14
    v_add_u32 v95, 138368, v95
k2_map_74:
    v_cmpx_lt_i32 vcc, 0, v96
    s_cbranch_execz k2_mapd_75
    v_min_u32 v93, 4, v96
    v_add3_u32 v93, v93, v94, -1
    ds_write_b32 v95, v93
    v_add_u32 v94, 64, v94
    v_add_u32 v95, 16, v95
    v_add_u32 v96, -16, v96
    s_branch k2_map_74
k2_mapd_75:
    s_mov_b64 exec, -1
    ds_read_b32 v18, v17 offset:8192
    v_lshlrev_b32 v80, 16, v40
    v_mul_f32 v80, v104, v80
    v_lshlrev_b32 v60, 16, v52
    v_and_b32 v61, v103, v52
    v_lshlrev_b32 v62, 16, v53
    v_and_b32 v63, v103, v53
    v_fma_f32 v60, v60, v80, v105
    v_fma_f32 v61, v61, v80, v105
    v_fma_f32 v62, v62, v80, v105
    v_fma_f32 v63, v63, v80, v105
    v_sub_u32 v60, v60, v105
    v_sub_u32 v61, v61, v105
    v_sub_u32 v62, v62, v105
    v_sub_u32 v63, v63, v105
    v_lshrrev_b32 v84, 16, v36
    v_and_b32 v81, v103, v40
    v_mul_f32 v81, v104, v81
    v_lshlrev_b32 v64, 16, v54
    v_and_b32 v65, v103, v54
    v_lshlrev_b32 v66, 16, v55
    v_and_b32 v67, v103, v55
    v_fma_f32 v64, v64, v81, v105
    v_fma_f32 v65, v65, v81, v105
    v_fma_f32 v66, v66, v81, v105
    v_fma_f32 v67, v67, v81, v105
    v_sub_u32 v64, v64, v105
    v_sub_u32 v65, v65, v105
    v_sub_u32 v66, v66, v105
    v_sub_u32 v67, v67, v105
    v_lshrrev_b32 v85, 16, v37
    s_waitcnt lgkmcnt(0)
    s_mov_b64 s[42:43], 0
    s_mov_b64 s[44:45], 0
    s_mov_b64 s[46:47], 0
    s_mov_b64 exec, s[40:41]
    s_cbranch_execz k2_lr_76
    v_and_b32 v35, -4, v34
    buffer_load_dwordx4 v[28:31], v35, s[24:27], 0 offen
    v_lshrrev_b32 v35, 1, v35
    buffer_load_dwordx2 v[32:33], v35, s[76:79], 0 offen
    v_and_b32 v34, 3, v34
    v_cmp_le_u32 s[42:43], 1, v34
    v_cmp_le_u32 s[44:45], 2, v34
    v_cmp_le_u32 s[46:47], 3, v34
k2_lr_76:
    s_mov_b64 exec, -1
    s_mov_b64 exec, s[48:49]
    ds_add_rtn_u64 v[60:61], v84, v[60:61]
    ds_add_rtn_u64 v[62:63], v84, v[62:63] offset:40000
    s_mov_b64 exec, -1
    s_mov_b64 exec, s[50:51]
    ds_add_rtn_u64 v[64:65], v85, v[64:65]
    ds_add_rtn_u64 v[66:67], v85, v[66:67] offset:40000
    s_mov_b64 exec, -1
    v_lshlrev_b32 v82, 16, v41
    v_mul_f32 v82, v104, v82
    v_lshlrev_b32 v68, 16, v56
    v_and_b32 v69, v103, v56
    v_lshlrev_b32 v70, 16, v57
    v_and_b32 v71, v103, v57
    v_fma_f32 v68, v68, v82, v105
    v_fma_f32 v69, v69, v82, v105
    v_fma_f32 v70, v70, v82, v105
    v_fma_f32 v71, v71, v82, v105
    v_sub_u32 v68, v68, v105
    v_sub_u32 v69, v69, v105
    v_sub_u32 v70, v70, v105
    v_sub_u32 v71, v71, v105
    v_lshrrev_b32 v86, 16, v38
    s_mov_b64 exec, s[52:53]
    ds_add_rtn_u64 v[68:69], v86, v[68:69]
    ds_add_rtn_u64 v[70:71], v86, v[70:71] offset:40000
    s_mov_b64 exec, -1
    v_and_b32 v83, v103, v41
    v_mul_f32 v83, v104, v83
    v_lshlrev_b32 v72, 16, v58
    v_and_b32 v73, v103, v58
    v_lshlrev_b32 v74, 16, v59
    v_and_b32 v75, v103, v59
    v_fma_f32 v72, v72, v83, v105
    v_fma_f32 v73, v73, v83, v105
    v_fma_f32 v74, v74, v83, v105
    v_fma_f32 v75, v75, v83, v105
    v_sub_u32 v72, v72, v105
    v_sub_u32 v73, v73, v105
    v_sub_u32 v74, v74, v105
    v_sub_u32 v75, v75, v105
    v_lshrrev_b32 v87, 16, v39
    s_mov_b64 exec, s[54:55]
    ds_add_rtn_u64 v[72:73], v87, v[72:73]
    ds_add_rtn_u64 v[74:75], v87, v[74:75] offset:40000
    s_mov_b64 exec, -1
    s_cmp_eq_u64 s[40:41], 0
    s_cbranch_scc1 k2_tw_77
    s_waitcnt vmcnt(2)
    s_branch k2_tw_78
k2_tw_77:
    s_waitcnt vmcnt(0)
k2_tw_78:
    s_barrier
    v_mad_u32_u16 v76, v44, 1, v101
    v_mad_u32_u16 v77, v45, 1, v101
    v_mad_u32_u16 v78, v46, 1, v101
    v_mad_u32_u16 v79, v47, 1, v101
    s_mov_b64 exec, s[56:57]
    ds_read_b64 v[52:53], v76
    s_mov_b64 exec, s[58:59]
    ds_read_b64 v[54:55], v77
    s_mov_b64 exec, s[60:61]
    ds_read_b64 v[56:57], v78
    s_mov_b64 exec, s[62:63]
    ds_read_b64 v[58:59], v79
    s_mov_b64 exec, -1
    s_waitcnt lgkmcnt(0)
    s_barrier
    ds_write_b128 v13, v[106:109] offset:0
    ds_write_b128 v13, v[110:113] offset:16384
    ds_write_b128 v13, v[114:117] offset:32768
    s_cmp_ge_u32 s84, 5
    s_cbranch_scc1 k2_wf_79
    ds_write_b128 v13, v[118:121] offset:49152
k2_wf_79:
    s_mul_i32 s91, s86, 53760
    s_add_u32 s92, s91, 1505280
    buffer_load_dwordx4 v[106:109], v1, s[20:23], s92 offen
    s_add_u32 s92, s91, 1521664
    buffer_load_dwordx4 v[110:113], v1, s[20:23], s92 offen
    s_add_u32 s92, s91, 1538048
    buffer_load_dwordx4 v[114:117], v1, s[20:23], s92 offen
    s_cmp_ge_u32 s84, 5
    s_cbranch_scc1 k2_lf_80
    s_add_u32 s92, s91, 1554432
    buffer_load_dwordx4 v[118:121], v1, s[20:23], s92 offen
k2_lf_80:
    s_mov_b64 exec, s[48:49]
    v_or3_b32 v100, v100, v60, v61
    v_or3_b32 v100, v100, v62, v63
    s_mov_b64 exec, s[50:51]
    v_or3_b32 v100, v100, v64, v65
    v_or3_b32 v100, v100, v66, v67
    s_mov_b64 exec, s[52:53]
    v_or3_b32 v100, v100, v68, v69
    v_or3_b32 v100, v100, v70, v71
    s_mov_b64 exec, s[54:55]
    v_or3_b32 v100, v100, v72, v73
    v_or3_b32 v100, v100, v74, v75
    s_mov_b64 exec, -1
    v_cmp_gt_u32 s[48:49], s71, v0
    v_add_u32 v91, 138368, v102
    ds_read_b32 v42, v91
    v_and_b32 v94, 0xffff, v18
    v_lshrrev_b32 v96, 26, v18
    v_bfe_u32 v95, v18, 16, 10
    v_sub_u32 v96, v96, v16
    v_add_lshl_u32 v95, v95, v15, 2
    v_lshl_add_u32 v94, v94, 2, v14
    v_add_u32 v95, 134272, v95
k2_map_81:
    v_cmpx_lt_i32 vcc, 0, v96
    s_cbranch_execz k2_mapd_82
    v_min_u32 v93, 4, v96
    v_add3_u32 v93, v93, v94, -1
    ds_write_b32 v95, v93
    v_add_u32 v94, 64, v94
    v_add_u32 v95, 16, v95
    v_add_u32 v96, -16, v96
    s_branch k2_map_81
k2_mapd_82:
    s_mov_b64 exec, -1
    ds_read_b32 v18, v17 offset:9216
    v_lshlrev_b32 v80, 16, v48
    v_mul_f32 v80, v104, v80
    v_lshlrev_b32 v60, 16, v52
    v_and_b32 v61, v103, v52
    v_lshlrev_b32 v62, 16, v53
    v_and_b32 v63, v103, v53
    v_fma_f32 v60, v60, v80, v105
    v_fma_f32 v61, v61, v80, v105
    v_fma_f32 v62, v62, v80, v105
    v_fma_f32 v63, v63, v80, v105
    v_sub_u32 v60, v60, v105
    v_sub_u32 v61, v61, v105
    v_sub_u32 v62, v62, v105
    v_sub_u32 v63, v63, v105
    v_lshrrev_b32 v84, 16, v44
    v_and_b32 v81, v103, v48
    v_mul_f32 v81, v104, v81
    v_lshlrev_b32 v64, 16, v54
    v_and_b32 v65, v103, v54
    v_lshlrev_b32 v66, 16, v55
    v_and_b32 v67, v103, v55
    v_fma_f32 v64, v64, v81, v105
    v_fma_f32 v65, v65, v81, v105
    v_fma_f32 v66, v66, v81, v105
    v_fma_f32 v67, v67, v81, v105
    v_sub_u32 v64, v64, v105
    v_sub_u32 v65, v65, v105
    v_sub_u32 v66, v66, v105
    v_sub_u32 v67, v67, v105
    v_lshrrev_b32 v85, 16, v45
    s_waitcnt lgkmcnt(0)
    s_mov_b64 s[50:51], 0
    s_mov_b64 s[52:53], 0
    s_mov_b64 s[54:55], 0
    s_mov_b64 exec, s[48:49]
    s_cbranch_execz k2_lr_83
    v_and_b32 v43, -4, v42
    buffer_load_dwordx4 v[36:39], v43, s[24:27], 0 offen
    v_lshrrev_b32 v43, 1, v43
    buffer_load_dwordx2 v[40:41], v43, s[76:79], 0 offen
    v_and_b32 v42, 3, v42
    v_cmp_le_u32 s[50:51], 1, v42
    v_cmp_le_u32 s[52:53], 2, v42
    v_cmp_le_u32 s[54:55], 3, v42
k2_lr_83:
    s_mov_b64 exec, -1
    s_mov_b64 exec, s[56:57]
    ds_add_rtn_u64 v[60:61], v84, v[60:61]
    ds_add_rtn_u64 v[62:63], v84, v[62:63] offset:40000
    s_mov_b64 exec, -1
    s_mov_b64 exec, s[58:59]
    ds_add_rtn_u64 v[64:65], v85, v[64:65]
    ds_add_rtn_u64 v[66:67], v85, v[66:67] offset:40000
    s_mov_b64 exec, -1
    v_lshlrev_b32 v82, 16, v49
    v_mul_f32 v82, v104, v82
    v_lshlrev_b32 v68, 16, v56
    v_and_b32 v69, v103, v56
    v_lshlrev_b32 v70, 16, v57
    v_and_b32 v71, v103, v57
    v_fma_f32 v68, v68, v82, v105
    v_fma_f32 v69, v69, v82, v105
    v_fma_f32 v70, v70, v82, v105
    v_fma_f32 v71, v71, v82, v105
    v_sub_u32 v68, v68, v105
    v_sub_u32 v69, v69, v105
    v_sub_u32 v70, v70, v105
    v_sub_u32 v71, v71, v105
    v_lshrrev_b32 v86, 16, v46
    s_mov_b64 exec, s[60:61]
    ds_add_rtn_u64 v[68:69], v86, v[68:69]
    ds_add_rtn_u64 v[70:71], v86, v[70:71] offset:40000
    s_mov_b64 exec, -1
    v_and_b32 v83, v103, v49
    v_mul_f32 v83, v104, v83
    v_lshlrev_b32 v72, 16, v58
    v_and_b32 v73, v103, v58
    v_lshlrev_b32 v74, 16, v59
    v_and_b32 v75, v103, v59
    v_fma_f32 v72, v72, v83, v105
    v_fma_f32 v73, v73, v83, v105
    v_fma_f32 v74, v74, v83, v105
    v_fma_f32 v75, v75, v83, v105
    v_sub_u32 v72, v72, v105
    v_sub_u32 v73, v73, v105
    v_sub_u32 v74, v74, v105
    v_sub_u32 v75, v75, v105
    v_lshrrev_b32 v87, 16, v47
    s_mov_b64 exec, s[62:63]
    ds_add_rtn_u64 v[72:73], v87, v[72:73]
    ds_add_rtn_u64 v[74:75], v87, v[74:75] offset:40000
    s_mov_b64 exec, -1
    s_cmp_eq_u64 s[48:49], 0
    s_cbranch_scc1 k2_tw_84
    s_waitcnt vmcnt(2)
    s_branch k2_tw_85
k2_tw_84:
    s_waitcnt vmcnt(0)
k2_tw_85:
    s_barrier
    v_mad_u32_u16 v76, v28, 1, v101
    v_mad_u32_u16 v77, v29, 1, v101
    v_mad_u32_u16 v78, v30, 1, v101
    v_mad_u32_u16 v79, v31, 1, v101
    s_mov_b64 exec, s[40:41]
    ds_read_b64 v[52:53], v76
    s_mov_b64 exec, s[42:43]
    ds_read_b64 v[54:55], v77
    s_mov_b64 exec, s[44:45]
    ds_read_b64 v[56:57], v78
    s_mov_b64 exec, s[46:47]
    ds_read_b64 v[58:59], v79
    s_mov_b64 exec, -1
    s_waitcnt lgkmcnt(0)
    s_barrier
    ds_write_b128 v13, v[106:109] offset:0
    ds_write_b128 v13, v[110:113] offset:16384
    ds_write_b128 v13, v[114:117] offset:32768
    s_cmp_ge_u32 s84, 5
    s_cbranch_scc1 k2_wf_86
    ds_write_b128 v13, v[118:121] offset:49152
k2_wf_86:
    s_mul_i32 s91, s86, 53760
    s_add_u32 s92, s91, 1720320
    buffer_load_dwordx4 v[106:109], v1, s[20:23], s92 offen
    s_add_u32 s92, s91, 1736704
    buffer_load_dwordx4 v[110:113], v1, s[20:23], s92 offen
    s_add_u32 s92, s91, 1753088
    buffer_load_dwordx4 v[114:117], v1, s[20:23], s92 offen
    s_cmp_ge_u32 s84, 5
    s_cbranch_scc1 k2_lf_87
    s_add_u32 s92, s91, 1769472
    buffer_load_dwordx4 v[118:121], v1, s[20:23], s92 offen
k2_lf_87:
    s_mov_b64 exec, s[56:57]
    v_or3_b32 v100, v100, v60, v61
    v_or3_b32 v100, v100, v62, v63
    s_mov_b64 exec, s[58:59]
    v_or3_b32 v100, v100, v64, v65
    v_or3_b32 v100, v100, v66, v67
    s_mov_b64 exec, s[60:61]
    v_or3_b32 v100, v100, v68, v69
    v_or3_b32 v100, v100, v70, v71
    s_mov_b64 exec, s[62:63]
    v_or3_b32 v100, v100, v72, v73
    v_or3_b32 v100, v100, v74, v75
    s_mov_b64 exec, -1
    v_cmp_gt_u32 s[56:57], s72, v0
    v_add_u32 v91, 134272, v102
    ds_read_b32 v50, v91
    v_and_b32 v94, 0xffff, v18
    v_lshrrev_b32 v96, 26, v18
    v_bfe_u32 v95, v18, 16, 10
    v_sub_u32 v96, v96, v16
    v_add_lshl_u32 v95, v95, v15, 2
    v_lshl_add_u32 v94, v94, 2, v14
    v_add_u32 v95, 138368, v95
k2_map_88:
    v_cmpx_lt_i32 vcc, 0, v96
    s_cbranch_execz k2_mapd_89
    v_min_u32 v93, 4, v96
    v_add3_u32 v93, v93, v94, -1
    ds_write_b32 v95, v93
    v_add_u32 v94, 64, v94
    v_add_u32 v95, 16, v95
    v_add_u32 v96, -16, v96
    s_branch k2_map_88
k2_mapd_89:
    s_mov_b64 exec, -1
    ds_read_b32 v18, v17 offset:10240
    v_lshlrev_b32 v80, 16, v32
    v_mul_f32 v80, v104, v80
    v_lshlrev_b32 v60, 16, v52
    v_and_b32 v61, v103, v52
    v_lshlrev_b32 v62, 16, v53
    v_and_b32 v63, v103, v53
    v_fma_f32 v60, v60, v80, v105
    v_fma_f32 v61, v61, v80, v105
    v_fma_f32 v62, v62, v80, v105
    v_fma_f32 v63, v63, v80, v105
    v_sub_u32 v60, v60, v105
    v_sub_u32 v61, v61, v105
    v_sub_u32 v62, v62, v105
    v_sub_u32 v63, v63, v105
    v_lshrrev_b32 v84, 16, v28
    v_and_b32 v81, v103, v32
    v_mul_f32 v81, v104, v81
    v_lshlrev_b32 v64, 16, v54
    v_and_b32 v65, v103, v54
    v_lshlrev_b32 v66, 16, v55
    v_and_b32 v67, v103, v55
    v_fma_f32 v64, v64, v81, v105
    v_fma_f32 v65, v65, v81, v105
    v_fma_f32 v66, v66, v81, v105
    v_fma_f32 v67, v67, v81, v105
    v_sub_u32 v64, v64, v105
    v_sub_u32 v65, v65, v105
    v_sub_u32 v66, v66, v105
    v_sub_u32 v67, v67, v105
    v_lshrrev_b32 v85, 16, v29
    s_waitcnt lgkmcnt(0)
    s_mov_b64 s[58:59], 0
    s_mov_b64 s[60:61], 0
    s_mov_b64 s[62:63], 0
    s_mov_b64 exec, s[56:57]
    s_cbranch_execz k2_lr_90
    v_and_b32 v51, -4, v50
    buffer_load_dwordx4 v[44:47], v51, s[24:27], 0 offen
    v_lshrrev_b32 v51, 1, v51
    buffer_load_dwordx2 v[48:49], v51, s[76:79], 0 offen
    v_and_b32 v50, 3, v50
    v_cmp_le_u32 s[58:59], 1, v50
    v_cmp_le_u32 s[60:61], 2, v50
    v_cmp_le_u32 s[62:63], 3, v50
k2_lr_90:
    s_mov_b64 exec, -1
    s_mov_b64 exec, s[40:41]
    ds_add_rtn_u64 v[60:61], v84, v[60:61]
    ds_add_rtn_u64 v[62:63], v84, v[62:63] offset:40000
    s_mov_b64 exec, -1
    s_mov_b64 exec, s[42:43]
    ds_add_rtn_u64 v[64:65], v85, v[64:65]
    ds_add_rtn_u64 v[66:67], v85, v[66:67] offset:40000
    s_mov_b64 exec, -1
    v_lshlrev_b32 v82, 16, v33
    v_mul_f32 v82, v104, v82
    v_lshlrev_b32 v68, 16, v56
    v_and_b32 v69, v103, v56
    v_lshlrev_b32 v70, 16, v57
    v_and_b32 v71, v103, v57
    v_fma_f32 v68, v68, v82, v105
    v_fma_f32 v69, v69, v82, v105
    v_fma_f32 v70, v70, v82, v105
    v_fma_f32 v71, v71, v82, v105
    v_sub_u32 v68, v68, v105
    v_sub_u32 v69, v69, v105
    v_sub_u32 v70, v70, v105
    v_sub_u32 v71, v71, v105
    v_lshrrev_b32 v86, 16, v30
    s_mov_b64 exec, s[44:45]
    ds_add_rtn_u64 v[68:69], v86, v[68:69]
    ds_add_rtn_u64 v[70:71], v86, v[70:71] offset:40000
    s_mov_b64 exec, -1
    v_and_b32 v83, v103, v33
    v_mul_f32 v83, v104, v83
    v_lshlrev_b32 v72, 16, v58
    v_and_b32 v73, v103, v58
    v_lshlrev_b32 v74, 16, v59
    v_and_b32 v75, v103, v59
    v_fma_f32 v72, v72, v83, v105
    v_fma_f32 v73, v73, v83, v105
    v_fma_f32 v74, v74, v83, v105
    v_fma_f32 v75, v75, v83, v105
    v_sub_u32 v72, v72, v105
    v_sub_u32 v73, v73, v105
    v_sub_u32 v74, v74, v105
    v_sub_u32 v75, v75, v105
    v_lshrrev_b32 v87, 16, v31
    s_mov_b64 exec, s[46:47]
    ds_add_rtn_u64 v[72:73], v87, v[72:73]
    ds_add_rtn_u64 v[74:75], v87, v[74:75] offset:40000
    s_mov_b64 exec, -1
    s_cmp_eq_u64 s[56:57], 0
    s_cbranch_scc1 k2_tw_91
    s_waitcnt vmcnt(2)
    s_branch k2_tw_92
k2_tw_91:
    s_waitcnt vmcnt(0)
k2_tw_92:
    s_barrier
    v_mad_u32_u16 v76, v36, 1, v101
    v_mad_u32_u16 v77, v37, 1, v101
    v_mad_u32_u16 v78, v38, 1, v101
    v_mad_u32_u16 v79, v39, 1, v101
    s_mov_b64 exec, s[48:49]
    ds_read_b64 v[52:53], v76
    s_mov_b64 exec, s[50:51]
    ds_read_b64 v[54:55], v77
    s_mov_b64 exec, s[52:53]
    ds_read_b64 v[56:57], v78
    s_mov_b64 exec, s[54:55]
    ds_read_b64 v[58:59], v79
    s_mov_b64 exec, -1
    s_waitcnt lgkmcnt(0)
    s_barrier
    ds_write_b128 v13, v[106:109] offset:0
    ds_write_b128 v13, v[110:113] offset:16384
    ds_write_b128 v13, v[114:117] offset:32768
    s_cmp_ge_u32 s84, 5
    s_cbranch_scc1 k2_wf_93
    ds_write_b128 v13, v[118:121] offset:49152
k2_wf_93:
    s_mul_i32 s91, s86, 53760
    s_add_u32 s92, s91, 1935360
    buffer_load_dwordx4 v[106:109], v1, s[20:23], s92 offen
    s_add_u32 s92, s91, 1951744
    buffer_load_dwordx4 v[110:113], v1, s[20:23], s92 offen
    s_add_u32 s92, s91, 1968128
    buffer_load_dwordx4 v[114:117], v1, s[20:23], s92 offen
    s_cmp_ge_u32 s84, 5
    s_cbranch_scc1 k2_lf_94
    s_add_u32 s92, s91, 1984512
    buffer_load_dwordx4 v[118:121], v1, s[20:23], s92 offen
k2_lf_94:
    s_mov_b64 exec, s[40:41]
    v_or3_b32 v100, v100, v60, v61
    v_or3_b32 v100, v100, v62, v63
    s_mov_b64 exec, s[42:43]
    v_or3_b32 v100, v100, v64, v65
    v_or3_b32 v100, v100, v66, v67
    s_mov_b64 exec, s[44:45]
    v_or3_b32 v100, v100, v68, v69
    v_or3_b32 v100, v100, v70, v71
    s_mov_b64 exec, s[46:47]
    v_or3_b32 v100, v100, v72, v73
    v_or3_b32 v100, v100, v74, v75
    s_mov_b64 exec, -1
    v_cmp_gt_u32 s[40:41], s73, v0
    v_add_u32 v91, 138368, v102
    ds_read_b32 v34, v91
    v_and_b32 v94, 0xffff, v18
    v_lshrrev_b32 v96, 26, v18
    v_bfe_u32 v95, v18, 16, 10
    v_sub_u32 v96, v96, v16
    v_add_lshl_u32 v95, v95, v15, 2
    v_lshl_add_u32 v94, v94, 2, v14
    v_add_u32 v95, 134272, v95
k2_map_95:
    v_cmpx_lt_i32 vcc, 0, v96
    s_cbranch_execz k2_mapd_96
    v_min_u32 v93, 4, v96
    v_add3_u32 v93, v93, v94, -1
    ds_write_b32 v95, v93
    v_add_u32 v94, 64, v94
    v_add_u32 v95, 16, v95
    v_add_u32 v96, -16, v96
    s_branch k2_map_95
k2_mapd_96:
    s_mov_b64 exec, -1
    ds_read_b32 v18, v17 offset:11264
    v_lshlrev_b32 v80, 16, v40
    v_mul_f32 v80, v104, v80
    v_lshlrev_b32 v60, 16, v52
    v_and_b32 v61, v103, v52
    v_lshlrev_b32 v62, 16, v53
    v_and_b32 v63, v103, v53
    v_fma_f32 v60, v60, v80, v105
    v_fma_f32 v61, v61, v80, v105
    v_fma_f32 v62, v62, v80, v105
    v_fma_f32 v63, v63, v80, v105
    v_sub_u32 v60, v60, v105
    v_sub_u32 v61, v61, v105
    v_sub_u32 v62, v62, v105
    v_sub_u32 v63, v63, v105
    v_lshrrev_b32 v84, 16, v36
    v_and_b32 v81, v103, v40
    v_mul_f32 v81, v104, v81
    v_lshlrev_b32 v64, 16, v54
    v_and_b32 v65, v103, v54
    v_lshlrev_b32 v66, 16, v55
    v_and_b32 v67, v103, v55
    v_fma_f32 v64, v64, v81, v105
    v_fma_f32 v65, v65, v81, v105
    v_fma_f32 v66, v66, v81, v105
    v_fma_f32 v67, v67, v81, v105
    v_sub_u32 v64, v64, v105
    v_sub_u32 v65, v65, v105
    v_sub_u32 v66, v66, v105
    v_sub_u32 v67, v67, v105
    v_lshrrev_b32 v85, 16, v37
    s_waitcnt lgkmcnt(0)
    s_mov_b64 s[42:43], 0
    s_mov_b64 s[44:45], 0
    s_mov_b64 s[46:47], 0
    s_mov_b64 exec, s[40:41]
    s_cbranch_execz k2_lr_97
    v_and_b32 v35, -4, v34
    buffer_load_dwordx4 v[28:31], v35, s[24:27], 0 offen
    v_lshrrev_b32 v35, 1, v35
    buffer_load_dwordx2 v[32:33], v35, s[76:79], 0 offen
    v_and_b32 v34, 3, v34
    v_cmp_le_u32 s[42:43], 1, v34
    v_cmp_le_u32 s[44:45], 2, v34
    v_cmp_le_u32 s[46:47], 3, v34
k2_lr_97:
    s_mov_b64 exec, -1
    s_mov_b64 exec, s[48:49]
    ds_add_rtn_u64 v[60:61], v84, v[60:61]
    ds_add_rtn_u64 v[62:63], v84, v[62:63] offset:40000
    s_mov_b64 exec, -1
    s_mov_b64 exec, s[50:51]
    ds_add_rtn_u64 v[64:65], v85, v[64:65]
    ds_add_rtn_u64 v[66:67], v85, v[66:67] offset:40000
    s_mov_b64 exec, -1
    v_lshlrev_b32 v82, 16, v41
    v_mul_f32 v82, v104, v82
    v_lshlrev_b32 v68, 16, v56
    v_and_b32 v69, v103, v56
    v_lshlrev_b32 v70, 16, v57
    v_and_b32 v71, v103, v57
    v_fma_f32 v68, v68, v82, v105
    v_fma_f32 v69, v69, v82, v105
    v_fma_f32 v70, v70, v82, v105
    v_fma_f32 v71, v71, v82, v105
    v_sub_u32 v68, v68, v105
    v_sub_u32 v69, v69, v105
    v_sub_u32 v70, v70, v105
    v_sub_u32 v71, v71, v105
    v_lshrrev_b32 v86, 16, v38
    s_mov_b64 exec, s[52:53]
    ds_add_rtn_u64 v[68:69], v86, v[68:69]
    ds_add_rtn_u64 v[70:71], v86, v[70:71] offset:40000
    s_mov_b64 exec, -1
    v_and_b32 v83, v103, v41
    v_mul_f32 v83, v104, v83
    v_lshlrev_b32 v72, 16, v58
    v_and_b32 v73, v103, v58
    v_lshlrev_b32 v74, 16, v59
    v_and_b32 v75, v103, v59
    v_fma_f32 v72, v72, v83, v105
    v_fma_f32 v73, v73, v83, v105
    v_fma_f32 v74, v74, v83, v105
    v_fma_f32 v75, v75, v83, v105
    v_sub_u32 v72, v72, v105
    v_sub_u32 v73, v73, v105
    v_sub_u32 v74, v74, v105
    v_sub_u32 v75, v75, v105
    v_lshrrev_b32 v87, 16, v39
    s_mov_b64 exec, s[54:55]
    ds_add_rtn_u64 v[72:73], v87, v[72:73]
    ds_add_rtn_u64 v[74:75], v87, v[74:75] offset:40000
    s_mov_b64 exec, -1
    s_cmp_eq_u64 s[40:41], 0
    s_cbranch_scc1 k2_tw_98
    s_waitcnt vmcnt(2)
    s_branch k2_tw_99
k2_tw_98:
    s_waitcnt vmcnt(0)
k2_tw_99:
    s_barrier
    v_mad_u32_u16 v76, v44, 1, v101
    v_mad_u32_u16 v77, v45, 1, v101
    v_mad_u32_u16 v78, v46, 1, v101
    v_mad_u32_u16 v79, v47, 1, v101
    s_mov_b64 exec, s[56:57]
    ds_read_b64 v[52:53], v76
    s_mov_b64 exec, s[58:59]
    ds_read_b64 v[54:55], v77
    s_mov_b64 exec, s[60:61]
    ds_read_b64 v[56:57], v78
    s_mov_b64 exec, s[62:63]
    ds_read_b64 v[58:59], v79
    s_mov_b64 exec, -1
    s_waitcnt lgkmcnt(0)
    s_barrier
    ds_write_b128 v13, v[106:109] offset:0
    ds_write_b128 v13, v[110:113] offset:16384
    ds_write_b128 v13, v[114:117] offset:32768
    s_cmp_ge_u32 s84, 5
    s_cbranch_scc1 k2_wf_100
    ds_write_b128 v13, v[118:121] offset:49152
k2_wf_100:
    s_mul_i32 s91, s86, 53760
    s_add_u32 s92, s91, 2150400
    buffer_load_dwordx4 v[106:109], v1, s[20:23], s92 offen
    s_add_u32 s92, s91, 2166784
    buffer_load_dwordx4 v[110:113], v1, s[20:23], s92 offen
    s_add_u32 s92, s91, 2183168
    buffer_load_dwordx4 v[114:117], v1, s[20:23], s92 offen
    s_cmp_ge_u32 s84, 5
    s_cbranch_scc1 k2_lf_101
    s_add_u32 s92, s91, 2199552
    buffer_load_dwordx4 v[118:121], v1, s[20:23], s92 offen
k2_lf_101:
    s_mov_b64 exec, s[48:49]
    v_or3_b32 v100, v100, v60, v61
    v_or3_b32 v100, v100, v62, v63
    s_mov_b64 exec, s[50:51]
    v_or3_b32 v100, v100, v64, v65
    v_or3_b32 v100, v100, v66, v67
    s_mov_b64 exec, s[52:53]
    v_or3_b32 v100, v100, v68, v69
    v_or3_b32 v100, v100, v70, v71
    s_mov_b64 exec, s[54:55]
    v_or3_b32 v100, v100, v72, v73
    v_or3_b32 v100, v100, v74, v75
    s_mov_b64 exec, -1
    v_cmp_gt_u32 s[48:49], s74, v0
    v_add_u32 v91, 134272, v102
    ds_read_b32 v42, v91
    v_and_b32 v94, 0xffff, v18
    v_lshrrev_b32 v96, 26, v18
    v_bfe_u32 v95, v18, 16, 10
    v_sub_u32 v96, v96, v16
    v_add_lshl_u32 v95, v95, v15, 2
    v_lshl_add_u32 v94, v94, 2, v14
    v_add_u32 v95, 138368, v95
k2_map_102:
    v_cmpx_lt_i32 vcc, 0, v96
    s_cbranch_execz k2_mapd_103
    v_min_u32 v93, 4, v96
    v_add3_u32 v93, v93, v94, -1
    ds_write_b32 v95, v93
    v_add_u32 v94, 64, v94
    v_add_u32 v95, 16, v95
    v_add_u32 v96, -16, v96
    s_branch k2_map_102
k2_mapd_103:
    s_mov_b64 exec, -1
    v_lshlrev_b32 v80, 16, v48
    v_mul_f32 v80, v104, v80
    v_lshlrev_b32 v60, 16, v52
    v_and_b32 v61, v103, v52
    v_lshlrev_b32 v62, 16, v53
    v_and_b32 v63, v103, v53
    v_fma_f32 v60, v60, v80, v105
    v_fma_f32 v61, v61, v80, v105
    v_fma_f32 v62, v62, v80, v105
    v_fma_f32 v63, v63, v80, v105
    v_sub_u32 v60, v60, v105
    v_sub_u32 v61, v61, v105
    v_sub_u32 v62, v62, v105
    v_sub_u32 v63, v63, v105
    v_lshrrev_b32 v84, 16, v44
    v_and_b32 v81, v103, v48
    v_mul_f32 v81, v104, v81
    v_lshlrev_b32 v64, 16, v54
    v_and_b32 v65, v103, v54
    v_lshlrev_b32 v66, 16, v55
    v_and_b32 v67, v103, v55
    v_fma_f32 v64, v64, v81, v105
    v_fma_f32 v65, v65, v81, v105
    v_fma_f32 v66, v66, v81, v105
    v_fma_f32 v67, v67, v81, v105
    v_sub_u32 v64, v64, v105
    v_sub_u32 v65, v65, v105
    v_sub_u32 v66, v66, v105
    v_sub_u32 v67, v67, v105
    v_lshrrev_b32 v85, 16, v45
    s_waitcnt lgkmcnt(0)
    s_mov_b64 s[50:51], 0
    s_mov_b64 s[52:53], 0
    s_mov_b64 s[54:55], 0
    s_mov_b64 exec, s[48:49]
    s_cbranch_execz k2_lr_104
    v_and_b32 v43, -4, v42
    buffer_load_dwordx4 v[36:39], v43, s[24:27], 0 offen
    v_lshrrev_b32 v43, 1, v43
    buffer_load_dwordx2 v[40:41], v43, s[76:79], 0 offen
    v_and_b32 v42, 3, v42
    v_cmp_le_u32 s[50:51], 1, v42
    v_cmp_le_u32 s[52:53], 2, v42
    v_cmp_le_u32 s[54:55], 3, v42
k2_lr_104:
    s_mov_b64 exec, -1
    s_mov_b64 exec, s[56:57]
    ds_add_rtn_u64 v[60:61], v84, v[60:61]
    ds_add_rtn_u64 v[62:63], v84, v[62:63] offset:40000
    s_mov_b64 exec, -1
    s_mov_b64 exec, s[58:59]
    ds_add_rtn_u64 v[64:65], v85, v[64:65]
    ds_add_rtn_u64 v[66:67], v85, v[66:67] offset:40000
    s_mov_b64 exec, -1
    v_lshlrev_b32 v82, 16, v49
    v_mul_f32 v82, v104, v82
    v_lshlrev_b32 v68, 16, v56
    v_and_b32 v69, v103, v56
    v_lshlrev_b32 v70, 16, v57
    v_and_b32 v71, v103, v57
    v_fma_f32 v68, v68, v82, v105
    v_fma_f32 v69, v69, v82, v105
    v_fma_f32 v70, v70, v82, v105
    v_fma_f32 v71, v71, v82, v105
    v_sub_u32 v68, v68, v105
    v_sub_u32 v69, v69, v105
    v_sub_u32 v70, v70, v105
    v_sub_u32 v71, v71, v105
    v_lshrrev_b32 v86, 16, v46
    s_mov_b64 exec, s[60:61]
    ds_add_rtn_u64 v[68:69], v86, v[68:69]
    ds_add_rtn_u64 v[70:71], v86, v[70:71] offset:40000
    s_mov_b64 exec, -1
    v_and_b32 v83, v103, v49
    v_mul_f32 v83, v104, v83
    v_lshlrev_b32 v72, 16, v58
    v_and_b32 v73, v103, v58
    v_lshlrev_b32 v74, 16, v59
    v_and_b32 v75, v103, v59
    v_fma_f32 v72, v72, v83, v105
    v_fma_f32 v73, v73, v83, v105
    v_fma_f32 v74, v74, v83, v105
    v_fma_f32 v75, v75, v83, v105
    v_sub_u32 v72, v72, v105
    v_sub_u32 v73, v73, v105
    v_sub_u32 v74, v74, v105
    v_sub_u32 v75, v75, v105
    v_lshrrev_b32 v87, 16, v47
    s_mov_b64 exec, s[62:63]
    ds_add_rtn_u64 v[72:73], v87, v[72:73]
    ds_add_rtn_u64 v[74:75], v87, v[74:75] offset:40000
    s_mov_b64 exec, -1
    s_cmp_eq_u64 s[48:49], 0
    s_cbranch_scc1 k2_tw_105
    s_waitcnt vmcnt(2)
    s_branch k2_tw_106
k2_tw_105:
    s_waitcnt vmcnt(0)
k2_tw_106:
    s_barrier
    v_mad_u32_u16 v76, v28, 1, v101
    v_mad_u32_u16 v77, v29, 1, v101
    v_mad_u32_u16 v78, v30, 1, v101
    v_mad_u32_u16 v79, v31, 1, v101
    s_mov_b64 exec, s[40:41]
    ds_read_b64 v[52:53], v76
    s_mov_b64 exec, s[42:43]
    ds_read_b64 v[54:55], v77
    s_mov_b64 exec, s[44:45]
    ds_read_b64 v[56:57], v78
    s_mov_b64 exec, s[46:47]
    ds_read_b64 v[58:59], v79
    s_mov_b64 exec, -1
    s_waitcnt lgkmcnt(0)
    s_barrier
    ds_write_b128 v13, v[106:109] offset:0
    ds_write_b128 v13, v[110:113] offset:16384
    ds_write_b128 v13, v[114:117] offset:32768
    s_cmp_ge_u32 s84, 5
    s_cbranch_scc1 k2_wf_107
    ds_write_b128 v13, v[118:121] offset:49152
k2_wf_107:
    s_mul_i32 s91, s86, 53760
    s_add_u32 s92, s91, 2365440
    buffer_load_dwordx4 v[106:109], v1, s[20:23], s92 offen
    s_add_u32 s92, s91, 2381824
    buffer_load_dwordx4 v[110:113], v1, s[20:23], s92 offen
    s_add_u32 s92, s91, 2398208
    buffer_load_dwordx4 v[114:117], v1, s[20:23], s92 offen
    s_cmp_ge_u32 s84, 5
    s_cbranch_scc1 k2_lf_108
    s_add_u32 s92, s91, 2414592
    buffer_load_dwordx4 v[118:121], v1, s[20:23], s92 offen
k2_lf_108:
    s_mov_b64 exec, s[56:57]
    v_or3_b32 v100, v100, v60, v61
    v_or3_b32 v100, v100, v62, v63
    s_mov_b64 exec, s[58:59]
    v_or3_b32 v100, v100, v64, v65
    v_or3_b32 v100, v100, v66, v67
    s_mov_b64 exec, s[60:61]
    v_or3_b32 v100, v100, v68, v69
    v_or3_b32 v100, v100, v70, v71
    s_mov_b64 exec, s[62:63]
    v_or3_b32 v100, v100, v72, v73
    v_or3_b32 v100, v100, v74, v75
    s_mov_b64 exec, -1
    v_cmp_gt_u32 s[56:57], s75, v0
    v_add_u32 v91, 138368, v102
    ds_read_b32 v50, v91
    v_lshlrev_b32 v80, 16, v32
    v_mul_f32 v80, v104, v80
    v_lshlrev_b32 v60, 16, v52
    v_and_b32 v61, v103, v52
    v_lshlrev_b32 v62, 16, v53
    v_and_b32 v63, v103, v53
    v_fma_f32 v60, v60, v80, v105
    v_fma_f32 v61, v61, v80, v105
    v_fma_f32 v62, v62, v80, v105
    v_fma_f32 v63, v63, v80, v105
    v_sub_u32 v60, v60, v105
    v_sub_u32 v61, v61, v105
    v_sub_u32 v62, v62, v105
    v_sub_u32 v63, v63, v105
    v_lshrrev_b32 v84, 16, v28
    v_and_b32 v81, v103, v32
    v_mul_f32 v81, v104, v81
    v_lshlrev_b32 v64, 16, v54
    v_and_b32 v65, v103, v54
    v_lshlrev_b32 v66, 16, v55
    v_and_b32 v67, v103, v55
    v_fma_f32 v64, v64, v81, v105
    v_fma_f32 v65, v65, v81, v105
    v_fma_f32 v66, v66, v81, v105
    v_fma_f32 v67, v67, v81, v105
    v_sub_u32 v64, v64, v105
    v_sub_u32 v65, v65, v105
    v_sub_u32 v66, v66, v105
    v_sub_u32 v67, v67, v105
    v_lshrrev_b32 v85, 16, v29
    s_waitcnt lgkmcnt(0)
    s_mov_b64 s[58:59], 0
    s_mov_b64 s[60:61], 0
    s_mov_b64 s[62:63], 0
    s_mov_b64 exec, s[56:57]
    s_cbranch_execz k2_lr_109
    v_and_b32 v51, -4, v50
    buffer_load_dwordx4 v[44:47], v51, s[24:27], 0 offen
    v_lshrrev_b32 v51, 1, v51
    buffer_load_dwordx2 v[48:49], v51, s[76:79], 0 offen
    v_and_b32 v50, 3, v50
    v_cmp_le_u32 s[58:59], 1, v50
    v_cmp_le_u32 s[60:61], 2, v50
    v_cmp_le_u32 s[62:63], 3, v50
k2_lr_109:
    s_mov_b64 exec, -1
    s_mov_b64 exec, s[40:41]
    ds_add_rtn_u64 v[60:61], v84, v[60:61]
    ds_add_rtn_u64 v[62:63], v84, v[62:63] offset:40000
    s_mov_b64 exec, -1
    s_mov_b64 exec, s[42:43]
    ds_add_rtn_u64 v[64:65], v85, v[64:65]
    ds_add_rtn_u64 v[66:67], v85, v[66:67] offset:40000
    s_mov_b64 exec, -1
    v_lshlrev_b32 v82, 16, v33
    v_mul_f32 v82, v104, v82
    v_lshlrev_b32 v68, 16, v56
    v_and_b32 v69, v103, v56
    v_lshlrev_b32 v70, 16, v57
    v_and_b32 v71, v103, v57
    v_fma_f32 v68, v68, v82, v105
    v_fma_f32 v69, v69, v82, v105
    v_fma_f32 v70, v70, v82, v105
    v_fma_f32 v71, v71, v82, v105
    v_sub_u32 v68, v68, v105
    v_sub_u32 v69, v69, v105
    v_sub_u32 v70, v70, v105
    v_sub_u32 v71, v71, v105
    v_lshrrev_b32 v86, 16, v30
    s_mov_b64 exec, s[44:45]
    ds_add_rtn_u64 v[68:69], v86, v[68:69]
    ds_add_rtn_u64 v[70:71], v86, v[70:71] offset:40000
    s_mov_b64 exec, -1
    v_and_b32 v83, v103, v33
    v_mul_f32 v83, v104, v83
    v_lshlrev_b32 v72, 16, v58
    v_and_b32 v73, v103, v58
    v_lshlrev_b32 v74, 16, v59
    v_and_b32 v75, v103, v59
    v_fma_f32 v72, v72, v83, v105
    v_fma_f32 v73, v73, v83, v105
    v_fma_f32 v74, v74, v83, v105
    v_fma_f32 v75, v75, v83, v105
    v_sub_u32 v72, v72, v105
    v_sub_u32 v73, v73, v105
    v_sub_u32 v74, v74, v105
    v_sub_u32 v75, v75, v105
    v_lshrrev_b32 v87, 16, v31
    s_mov_b64 exec, s[46:47]
    ds_add_rtn_u64 v[72:73], v87, v[72:73]
    ds_add_rtn_u64 v[74:75], v87, v[74:75] offset:40000
    s_mov_b64 exec, -1
    s_cmp_eq_u64 s[56:57], 0
    s_cbranch_scc1 k2_tw_110
    s_waitcnt vmcnt(2)
    s_branch k2_tw_111
k2_tw_110:
    s_waitcnt vmcnt(0)
k2_tw_111:
    s_barrier
    v_mad_u32_u16 v76, v36, 1, v101
    v_mad_u32_u16 v77, v37, 1, v101
    v_mad_u32_u16 v78, v38, 1, v101
    v_mad_u32_u16 v79, v39, 1, v101
    s_mov_b64 exec, s[48:49]
    ds_read_b64 v[52:53], v76
    s_mov_b64 exec, s[50:51]
    ds_read_b64 v[54:55], v77
    s_mov_b64 exec, s[52:53]
    ds_read_b64 v[56:57], v78
    s_mov_b64 exec, s[54:55]
    ds_read_b64 v[58:59], v79
    s_mov_b64 exec, -1
    s_waitcnt lgkmcnt(0)
    s_barrier
    ds_write_b128 v13, v[106:109] offset:0
    ds_write_b128 v13, v[110:113] offset:16384
    ds_write_b128 v13, v[114:117] offset:32768
    s_cmp_ge_u32 s84, 5
    s_cbranch_scc1 k2_wf_112
    ds_write_b128 v13, v[118:121] offset:49152
k2_wf_112:
    s_mov_b64 exec, s[40:41]
    v_or3_b32 v100, v100, v60, v61
    v_or3_b32 v100, v100, v62, v63
    s_mov_b64 exec, s[42:43]
    v_or3_b32 v100, v100, v64, v65
    v_or3_b32 v100, v100, v66, v67
    s_mov_b64 exec, s[44:45]
    v_or3_b32 v100, v100, v68, v69
    v_or3_b32 v100, v100, v70, v71
    s_mov_b64 exec, s[46:47]
    v_or3_b32 v100, v100, v72, v73
    v_or3_b32 v100, v100, v74, v75
    s_mov_b64 exec, -1
    v_lshlrev_b32 v80, 16, v40
    v_mul_f32 v80, v104, v80
    v_lshlrev_b32 v60, 16, v52
    v_and_b32 v61, v103, v52
    v_lshlrev_b32 v62, 16, v53
    v_and_b32 v63, v103, v53
    v_fma_f32 v60, v60, v80, v105
    v_fma_f32 v61, v61, v80, v105
    v_fma_f32 v62, v62, v80, v105
    v_fma_f32 v63, v63, v80, v105
    v_sub_u32 v60, v60, v105
    v_sub_u32 v61, v61, v105
    v_sub_u32 v62, v62, v105
    v_sub_u32 v63, v63, v105
    v_lshrrev_b32 v84, 16, v36
    v_and_b32 v81, v103, v40
    v_mul_f32 v81, v104, v81
    v_lshlrev_b32 v64, 16, v54
    v_and_b32 v65, v103, v54
    v_lshlrev_b32 v66, 16, v55
    v_and_b32 v67, v103, v55
    v_fma_f32 v64, v64, v81, v105
    v_fma_f32 v65, v65, v81, v105
    v_fma_f32 v66, v66, v81, v105
    v_fma_f32 v67, v67, v81, v105
    v_sub_u32 v64, v64, v105
    v_sub_u32 v65, v65, v105
    v_sub_u32 v66, v66, v105
    v_sub_u32 v67, v67, v105
    v_lshrrev_b32 v85, 16, v37
    s_waitcnt lgkmcnt(0)
    s_mov_b64 exec, s[48:49]
    ds_add_rtn_u64 v[60:61], v84, v[60:61]
    ds_add_rtn_u64 v[62:63], v84, v[62:63] offset:40000
    s_mov_b64 exec, -1
    s_mov_b64 exec, s[50:51]
    ds_add_rtn_u64 v[64:65], v85, v[64:65]
    ds_add_rtn_u64 v[66:67], v85, v[66:67] offset:40000
    s_mov_b64 exec, -1
    v_lshlrev_b32 v82, 16, v41
    v_mul_f32 v82, v104, v82
    v_lshlrev_b32 v68, 16, v56
    v_and_b32 v69, v103, v56
    v_lshlrev_b32 v70, 16, v57
    v_and_b32 v71, v103, v57
    v_fma_f32 v68, v68, v82, v105
    v_fma_f32 v69, v69, v82, v105
    v_fma_f32 v70, v70, v82, v105
    v_fma_f32 v71, v71, v82, v105
    v_sub_u32 v68, v68, v105
    v_sub_u32 v69, v69, v105
    v_sub_u32 v70, v70, v105
    v_sub_u32 v71, v71, v105
    v_lshrrev_b32 v86, 16, v38
    s_mov_b64 exec, s[52:53]
    ds_add_rtn_u64 v[68:69], v86, v[68:69]
    ds_add_rtn_u64 v[70:71], v86, v[70:71] offset:40000
    s_mov_b64 exec, -1
    v_and_b32 v83, v103, v41
    v_mul_f32 v83, v104, v83
    v_lshlrev_b32 v72, 16, v58
    v_and_b32 v73, v103, v58
    v_lshlrev_b32 v74, 16, v59
    v_and_b32 v75, v103, v59
    v_fma_f32 v72, v72, v83, v105
    v_fma_f32 v73, v73, v83, v105
    v_fma_f32 v74, v74, v83, v105
    v_fma_f32 v75, v75, v83, v105
    v_sub_u32 v72, v72, v105
    v_sub_u32 v73, v73, v105
    v_sub_u32 v74, v74, v105
    v_sub_u32 v75, v75, v105
    v_lshrrev_b32 v87, 16, v39
    s_mov_b64 exec, s[54:55]
    ds_add_rtn_u64 v[72:73], v87, v[72:73]
    ds_add_rtn_u64 v[74:75], v87, v[74:75] offset:40000
    s_mov_b64 exec, -1
    s_waitcnt vmcnt(0)
    s_barrier
    v_mad_u32_u16 v76, v44, 1, v101
    v_mad_u32_u16 v77, v45, 1, v101
    v_mad_u32_u16 v78, v46, 1, v101
    v_mad_u32_u16 v79, v47, 1, v101
    s_mov_b64 exec, s[56:57]
    ds_read_b64 v[52:53], v76
    s_mov_b64 exec, s[58:59]
    ds_read_b64 v[54:55], v77
    s_mov_b64 exec, s[60:61]
    ds_read_b64 v[56:57], v78
    s_mov_b64 exec, s[62:63]
    ds_read_b64 v[58:59], v79
    s_mov_b64 exec, -1
    s_waitcnt lgkmcnt(0)
    s_barrier
    s_mov_b64 exec, s[48:49]
    v_or3_b32 v100, v100, v60, v61
    v_or3_b32 v100, v100, v62, v63
    s_mov_b64 exec, s[50:51]
    v_or3_b32 v100, v100, v64, v65
    v_or3_b32 v100, v100, v66, v67
    s_mov_b64 exec, s[52:53]
    v_or3_b32 v100, v100, v68, v69
    v_or3_b32 v100, v100, v70, v71
    s_mov_b64 exec, s[54:55]
    v_or3_b32 v100, v100, v72, v73
    v_or3_b32 v100, v100, v74, v75
    s_mov_b64 exec, -1
    v_lshlrev_b32 v80, 16, v48
    v_mul_f32 v80, v104, v80
    v_lshlrev_b32 v60, 16, v52
    v_and_b32 v61, v103, v52
    v_lshlrev_b32 v62, 16, v53
    v_and_b32 v63, v103, v53
    v_fma_f32 v60, v60, v80, v105
    v_fma_f32 v61, v61, v80, v105
    v_fma_f32 v62, v62, v80, v105
    v_fma_f32 v63, v63, v80, v105
    v_sub_u32 v60, v60, v105
    v_sub_u32 v61, v61, v105
    v_sub_u32 v62, v62, v105
    v_sub_u32 v63, v63, v105
    v_lshrrev_b32 v84, 16, v44
    v_and_b32 v81, v103, v48
    v_mul_f32 v81, v104, v81
    v_lshlrev_b32 v64, 16, v54
    v_and_b32 v65, v103, v54
    v_lshlrev_b32 v66, 16, v55
    v_and_b32 v67, v103, v55
    v_fma_f32 v64, v64, v81, v105
    v_fma_f32 v65, v65, v81, v105
    v_fma_f32 v66, v66, v81, v105
    v_fma_f32 v67, v67, v81, v105
    v_sub_u32 v64, v64, v105
    v_sub_u32 v65, v65, v105
    v_sub_u32 v66, v66, v105
    v_sub_u32 v67, v67, v105
    v_lshrrev_b32 v85, 16, v45
    s_mov_b64 exec, s[56:57]
    ds_add_rtn_u64 v[60:61], v84, v[60:61]
    ds_add_rtn_u64 v[62:63], v84, v[62:63] offset:40000
    s_mov_b64 exec, -1
    s_mov_b64 exec, s[58:59]
    ds_add_rtn_u64 v[64:65], v85, v[64:65]
    ds_add_rtn_u64 v[66:67], v85, v[66:67] offset:40000
    s_mov_b64 exec, -1
    v_lshlrev_b32 v82, 16, v49
    v_mul_f32 v82, v104, v82
    v_lshlrev_b32 v68, 16, v56
    v_and_b32 v69, v103, v56
    v_lshlrev_b32 v70, 16, v57
    v_and_b32 v71, v103, v57
    v_fma_f32 v68, v68, v82, v105
    v_fma_f32 v69, v69, v82, v105
    v_fma_f32 v70, v70, v82, v105
    v_fma_f32 v71, v71, v82, v105
    v_sub_u32 v68, v68, v105
    v_sub_u32 v69, v69, v105
    v_sub_u32 v70, v70, v105
    v_sub_u32 v71, v71, v105
    v_lshrrev_b32 v86, 16, v46
    s_mov_b64 exec, s[60:61]
    ds_add_rtn_u64 v[68:69], v86, v[68:69]
    ds_add_rtn_u64 v[70:71], v86, v[70:71] offset:40000
    s_mov_b64 exec, -1
    v_and_b32 v83, v103, v49
    v_mul_f32 v83, v104, v83
    v_lshlrev_b32 v72, 16, v58
    v_and_b32 v73, v103, v58
    v_lshlrev_b32 v74, 16, v59
    v_and_b32 v75, v103, v59
    v_fma_f32 v72, v72, v83, v105
    v_fma_f32 v73, v73, v83, v105
    v_fma_f32 v74, v74, v83, v105
    v_fma_f32 v75, v75, v83, v105
    v_sub_u32 v72, v72, v105
    v_sub_u32 v73, v73, v105
    v_sub_u32 v74, v74, v105
    v_sub_u32 v75, v75, v105
    v_lshrrev_b32 v87, 16, v47
    s_mov_b64 exec, s[62:63]
    ds_add_rtn_u64 v[72:73], v87, v[72:73]
    ds_add_rtn_u64 v[74:75], v87, v[74:75] offset:40000
    s_mov_b64 exec, -1
    s_waitcnt lgkmcnt(0)
    s_mov_b64 exec, s[56:57]
    v_or3_b32 v100, v100, v60, v61
    v_or3_b32 v100, v100, v62, v63
    s_mov_b64 exec, s[58:59]
    v_or3_b32 v100, v100, v64, v65
    v_or3_b32 v100, v100, v66, v67
    s_mov_b64 exec, s[60:61]
    v_or3_b32 v100, v100, v68, v69
    v_or3_b32 v100, v100, v70, v71
    s_mov_b64 exec, s[62:63]
    v_or3_b32 v100, v100, v72, v73
    v_or3_b32 v100, v100, v74, v75
    s_mov_b64 exec, -1
    v_cmp_gt_i32 vcc, 0, v100
    v_mov_b32 v77, 155776
    s_cbranch_vccz k2_flag2
    v_mov_b32 v78, 1
    ds_write_b32 v77, v78
    s_waitcnt lgkmcnt(0)
k2_flag2:
    s_barrier
    ds_read_b32 v78, v77
    s_waitcnt lgkmcnt(0)
    v_readfirstlane_b32 s90, v78
    s_nop 3
    s_cmp_lg_u32 s90, 0
    s_cbranch_scc1 k2_slow
k2_epi:
    v_lshlrev_b32 v96, 3, v0
    v_add_u32 v97, 40000, v1
    ds_read_b128 v[28:31], v1 offset:0
    ds_read_b128 v[32:35], v97 offset:0
    ds_read_b128 v[36:39], v1 offset:16384
    ds_read_b128 v[40:43], v97 offset:16384
    ds_read_b128 v[44:47], v1 offset:32768
    ds_read_b128 v[48:51], v97 offset:32768
    s_mul_i32 s85, s86, 1250
    s_lshl_b32 s82, s85, 3
    v_add_u32 v95, s82, v96
    ds_read_b64 v[52:53], v95 offset:0
    ds_read_b64 v[54:55], v95 offset:40000
    ds_read_b64 v[60:61], v95 offset:8192
    ds_read_b64 v[62:63], v95 offset:48192
    s_add_u32 s18, s6, 103829504
    s_addc_u32 s19, s7, 0
    s_load_dwordx16 s[40:55], s[18:19], 0
    s_load_dwordx16 s[56:71], s[18:19], 64
    s_lshl_b32 s15, s14, 3
    s_add_u32 s28, s4, s15
    s_addc_u32 s29, s5, 0
    s_and_b32 s29, s29, 0xffff
    s_mov_b32 s30, 10000
    s_mov_b32 s31, 0x20000
    v_add_u32 v84, 0, v0
    v_lshlrev_b32 v58, 3, v84
    buffer_load_dwordx2 v[56:57], v58, s[28:31], 0 offen
    v_add_u32 v84, 1024, v0
    v_lshlrev_b32 v70, 3, v84
    buffer_load_dwordx2 v[68:69], v70, s[28:31], 0 offen
    s_add_u32 s20, s10, s15
    s_addc_u32 s21, s11, 0
    s_and_b32 s21, s21, 0xffff
    s_mov_b32 s22, 10000
    s_mov_b32 s23, 0x20000
    s_add_u32 s72, s6, s15
    s_addc_u32 s73, s7, 0
    s_add_u32 s72, s72, 124309760
    s_addc_u32 s73, s73, 0
    s_and_b32 s73, s73, 0xffff
    s_mov_b32 s74, 7690000
    s_mov_b32 s75, 0x20000
    s_lshl_b32 s15, s14, 4
    s_add_u32 s24, s6, s15
    s_addc_u32 s25, s7, 0
    s_add_u32 s24, s24, 103829760
    s_addc_u32 s25, s25, 0
    s_and_b32 s25, s25, 0xffff
    s_mov_b32 s26, 15380000
    s_mov_b32 s27, 0x20000
    s_mul_i32 s80, s86, 2560000
    s_mul_i32 s81, s87, 40000
    s_add_u32 s80, s80, s81
    s_add_u32 s32, s6, s80
    s_addc_u32 s33, s7, 0
    s_add_u32 s32, s32, 124309760
    s_addc_u32 s33, s33, 0
    s_and_b32 s33, s33, 0xffff
    s_mov_b32 s34, 40000
    s_mov_b32 s35, 0x20000
    s_waitcnt lgkmcnt(0)
    s_cmp_lg_u32 s89, 0
    s_cbranch_scc1 k2_epi_slow
    v_mov_b32 v98, 0x40000000
    v_mov_b32 v99, 0x34800000
    s_lshr_b32 s81, s85, 1
    v_sub_u32 v28, v28, v98
    v_sub_u32 v29, v29, v98
    v_sub_u32 v30, v30, v98
    v_sub_u32 v31, v31, v98
    v_sub_u32 v32, v32, v98
    v_sub_u32 v33, v33, v98
    v_sub_u32 v34, v34, v98
    v_sub_u32 v35, v35, v98
    v_cvt_f32_i32 v28, v28
    v_cvt_f32_i32 v29, v29
    v_cvt_f32_i32 v30, v30
    v_cvt_f32_i32 v31, v31
    v_cvt_f32_i32 v32, v32
    v_cvt_f32_i32 v33, v33
    v_cvt_f32_i32 v34, v34
    v_cvt_f32_i32 v35, v35
    v_mul_f32 v28, v99, v28
    v_mul_f32 v29, v99, v29
    v_mul_f32 v30, v99, v30
    v_mul_f32 v31, v99, v31
    v_mul_f32 v32, v99, v32
    v_mul_f32 v33, v99, v33
    v_mul_f32 v34, v99, v34
    v_mul_f32 v35, v99, v35
    v_cvt_pk_f16_f32 v28, v28, v29
    v_cvt_pk_f16_f32 v29, v32, v33
    v_cvt_pk_f16_f32 v30, v30, v31
    v_cvt_pk_f16_f32 v31, v34, v35
    v_add_u32 v94, 0, v0
    v_subrev_u32 v94, s81, v94
    v_cmp_le_u32 vcc, 625, v94
    s_mov_b64 exec, vcc
    s_cbranch_execz k2_sk_113
    s_mov_b32 s90, 0
    buffer_store_dwordx4 v[28:31], v1, s[32:35], s90 offen sc0 sc1
k2_sk_113:
    s_mov_b64 exec, -1
    v_sub_u32 v36, v36, v98
    v_sub_u32 v37, v37, v98
    v_sub_u32 v38, v38, v98
    v_sub_u32 v39, v39, v98
    v_sub_u32 v40, v40, v98
    v_sub_u32 v41, v41, v98
    v_sub_u32 v42, v42, v98
    v_sub_u32 v43, v43, v98
    v_cvt_f32_i32 v36, v36
    v_cvt_f32_i32 v37, v37
    v_cvt_f32_i32 v38, v38
    v_cvt_f32_i32 v39, v39
    v_cvt_f32_i32 v40, v40
    v_cvt_f32_i32 v41, v41
    v_cvt_f32_i32 v42, v42
    v_cvt_f32_i32 v43, v43
    v_mul_f32 v36, v99, v36
    v_mul_f32 v37, v99, v37
    v_mul_f32 v38, v99, v38
    v_mul_f32 v39, v99, v39
    v_mul_f32 v40, v99, v40
    v_mul_f32 v41, v99, v41
    v_mul_f32 v42, v99, v42
    v_mul_f32 v43, v99, v43
    v_cvt_pk_f16_f32 v36, v36, v37
    v_cvt_pk_f16_f32 v37, v40, v41
    v_cvt_pk_f16_f32 v38, v38, v39
    v_cvt_pk_f16_f32 v39, v42, v43
    v_add_u32 v94, 1024, v0
    v_subrev_u32 v94, s81, v94
    v_cmp_le_u32 vcc, 625, v94
    s_mov_b64 exec, vcc
    s_cbranch_execz k2_sk_114
    s_mov_b32 s90, 16384
    buffer_store_dwordx4 v[36:39], v1, s[32:35], s90 offen sc0 sc1
k2_sk_114:
    s_mov_b64 exec, -1
    v_sub_u32 v44, v44, v98
    v_sub_u32 v45, v45, v98
    v_sub_u32 v46, v46, v98
    v_sub_u32 v47, v47, v98
    v_sub_u32 v48, v48, v98
    v_sub_u32 v49, v49, v98
    v_sub_u32 v50, v50, v98
    v_sub_u32 v51, v51, v98
    v_cvt_f32_i32 v44, v44
    v_cvt_f32_i32 v45, v45
    v_cvt_f32_i32 v46, v46
    v_cvt_f32_i32 v47, v47
    v_cvt_f32_i32 v48, v48
    v_cvt_f32_i32 v49, v49
    v_cvt_f32_i32 v50, v50
    v_cvt_f32_i32 v51, v51
    v_mul_f32 v44, v99, v44
    v_mul_f32 v45, v99, v45
    v_mul_f32 v46, v99, v46
    v_mul_f32 v47, v99, v47
    v_mul_f32 v48, v99, v48
    v_mul_f32 v49, v99, v49
    v_mul_f32 v50, v99, v50
    v_mul_f32 v51, v99, v51
    v_cvt_pk_f16_f32 v44, v44, v45
    v_cvt_pk_f16_f32 v45, v48, v49
    v_cvt_pk_f16_f32 v46, v46, v47
    v_cvt_pk_f16_f32 v47, v50, v51
    v_add_u32 v94, 2048, v0
    v_subrev_u32 v94, s81, v94
    v_cmp_le_u32 vcc, 625, v94
    s_mov_b64 exec, vcc
    s_cbranch_execz k2_sk_115
    s_mov_b32 s90, 32768
    buffer_store_dwordx4 v[44:47], v1, s[32:35], s90 offen sc0 sc1
k2_sk_115:
    s_mov_b64 exec, -1
    v_mov_b32 v99, s83
    v_sub_u32 v52, v52, v98
    v_sub_u32 v53, v53, v98
    v_sub_u32 v54, v54, v98
    v_sub_u32 v55, v55, v98
    v_cvt_f32_i32 v52, v52
    v_cvt_f32_i32 v53, v53
    v_cvt_f32_i32 v54, v54
    v_cvt_f32_i32 v55, v55
    v_mul_f32 v52, v99, v52
    v_mul_f32 v53, v99, v53
    v_mul_f32 v54, v99, v54
    v_mul_f32 v55, v99, v55
    v_sub_u32 v60, v60, v98
    v_sub_u32 v61, v61, v98
    v_sub_u32 v62, v62, v98
    v_sub_u32 v63, v63, v98
    v_cvt_f32_i32 v60, v60
    v_cvt_f32_i32 v61, v61
    v_cvt_f32_i32 v62, v62
    v_cvt_f32_i32 v63, v63
    v_mul_f32 v60, v99, v60
    v_mul_f32 v61, v99, v61
    v_mul_f32 v62, v99, v62
    v_mul_f32 v63, v99, v63
    v_mov_b32 v77, 1
    s_branch k2_epi_pub
k2_epi_slow:
    v_lshlrev_b32 v94, 5, v0
    v_swap_b32 v30, v32
    v_swap_b32 v31, v33
    s_mov_b32 s90, 0
    s_nop 1
    buffer_store_dwordx4 v[28:31], v94, s[36:39], s90 offen sc0 sc1
    buffer_store_dwordx4 v[32:35], v94, s[36:39], s90 offen offset:16 sc0 sc1
    v_swap_b32 v38, v40
    v_swap_b32 v39, v41
    s_mov_b32 s90, 32768
    s_nop 1
    buffer_store_dwordx4 v[36:39], v94, s[36:39], s90 offen sc0 sc1
    buffer_store_dwordx4 v[40:43], v94, s[36:39], s90 offen offset:16 sc0 sc1
    v_swap_b32 v46, v48
    v_swap_b32 v47, v49
    s_mov_b32 s90, 65536
    s_nop 1
    buffer_store_dwordx4 v[44:47], v94, s[36:39], s90 offen sc0 sc1
    buffer_store_dwordx4 v[48:51], v94, s[36:39], s90 offen offset:16 sc0 sc1
    s_add_u32 s90, s86, 8
    s_lshl_b32 s90, 1, s90
    s_or_b32 s90, s90, 1
    v_mov_b32 v77, s90
k2_epi_pub:
    s_waitcnt vmcnt(0)
    s_barrier
    s_cmp_lg_u32 s84, 15
    s_cbranch_scc1 k2_fw_noadd
    s_lshl_b32 s80, s87, 8
    s_add_u32 s80, s80, 103813120
    s_add_u32 s12, s6, s80
    s_addc_u32 s13, s7, 0
    v_mov_b32 v80, 0
    s_mov_b64 exec, 1
    global_atomic_add v81, v80, v77, s[12:13] sc0 sc1
    s_mov_b64 exec, -1
k2_fw_noadd:
    v_lshlrev_b32 v5, 16, v5
    v_mov_b32 v20, v5
    v_subrev_f32 v21, 0x3e120000, v5
    v_subrev_f32 v22, 0x3e920000, v5
    v_subrev_f32 v23, 0x3edb0000, v5
    v_subrev_f32 v24, 0x3f120000, v5
    v_subrev_f32 v25, 0x3f370000, v5
    v_subrev_f32 v26, 0x3f5b0000, v5
    v_subrev_f32 v27, 0x3f800000, v5
    v_cvt_pk_bf16_f32 v20, v20, v21
    v_and_b32 v21, v103, v20
    v_lshlrev_b32 v20, 16, v20
    v_cvt_pk_bf16_f32 v22, v22, v23
    v_and_b32 v23, v103, v22
    v_lshlrev_b32 v22, 16, v22
    v_cvt_pk_bf16_f32 v24, v24, v25
    v_and_b32 v25, v103, v24
    v_lshlrev_b32 v24, 16, v24
    v_cvt_pk_bf16_f32 v26, v26, v27
    v_and_b32 v27, v103, v26
    v_lshlrev_b32 v26, 16, v26
    v_mul_f32 v20, v20, v20
    v_mul_f32 v21, v21, v21
    v_mul_f32 v22, v22, v22
    v_mul_f32 v23, v23, v23
    v_mul_f32 v24, v24, v24
    v_mul_f32 v25, v25, v25
    v_mul_f32 v26, v26, v26
    v_mul_f32 v27, v27, v27
    v_cvt_pk_bf16_f32 v20, v20, v21
    v_and_b32 v21, v103, v20
    v_lshlrev_b32 v20, 16, v20
    v_cvt_pk_bf16_f32 v22, v22, v23
    v_and_b32 v23, v103, v22
    v_lshlrev_b32 v22, 16, v22
    v_cvt_pk_bf16_f32 v24, v24, v25
    v_and_b32 v25, v103, v24
    v_lshlrev_b32 v24, 16, v24
    v_cvt_pk_bf16_f32 v26, v26, v27
    v_and_b32 v27, v103, v26
    v_lshlrev_b32 v26, 16, v26
    v_mul_f32 v20, 0xc1200000, v20
    v_mul_f32 v21, 0xc1200000, v21
    v_mul_f32 v22, 0xc1200000, v22
    v_mul_f32 v23, 0xc1200000, v23
    v_mul_f32 v24, 0xc1200000, v24
    v_mul_f32 v25, 0xc1200000, v25
    v_mul_f32 v26, 0xc1200000, v26
    v_mul_f32 v27, 0xc1200000, v27
    v_cvt_pk_bf16_f32 v20, v20, v21
    v_and_b32 v21, v103, v20
    v_lshlrev_b32 v20, 16, v20
    v_cvt_pk_bf16_f32 v22, v22, v23
    v_and_b32 v23, v103, v22
    v_lshlrev_b32 v22, 16, v22
    v_cvt_pk_bf16_f32 v24, v24, v25
    v_and_b32 v25, v103, v24
    v_lshlrev_b32 v24, 16, v24
    v_cvt_pk_bf16_f32 v26, v26, v27
    v_and_b32 v27, v103, v26
    v_lshlrev_b32 v26, 16, v26
    v_mul_f32 v20, 0x3fb8aa3b, v20
    v_mul_f32 v21, 0x3fb8aa3b, v21
    v_mul_f32 v22, 0x3fb8aa3b, v22
    v_mul_f32 v23, 0x3fb8aa3b, v23
    v_mul_f32 v24, 0x3fb8aa3b, v24
    v_mul_f32 v25, 0x3fb8aa3b, v25
    v_mul_f32 v26, 0x3fb8aa3b, v26
    v_mul_f32 v27, 0x3fb8aa3b, v27
    v_exp_f32 v20, v20
    v_exp_f32 v21, v21
    v_exp_f32 v22, v22
    v_exp_f32 v23, v23
    v_exp_f32 v24, v24
    v_exp_f32 v25, v25
    v_exp_f32 v26, v26
    v_exp_f32 v27, v27
    s_nop 0
    v_cvt_pk_bf16_f32 v118, v20, v21
    v_cvt_pk_bf16_f32 v119, v22, v23
    v_cvt_pk_bf16_f32 v120, v24, v25
    v_cvt_pk_bf16_f32 v121, v26, v27
    s_cmp_ge_u32 s84, 4
    s_cbranch_scc1 k2_e_116
    v_lshlrev_b32 v9, 16, v9
    v_mov_b32 v20, v9
    v_subrev_f32 v21, 0x3e120000, v9
    v_subrev_f32 v22, 0x3e920000, v9
    v_subrev_f32 v23, 0x3edb0000, v9
    v_subrev_f32 v24, 0x3f120000, v9
    v_subrev_f32 v25, 0x3f370000, v9
    v_subrev_f32 v26, 0x3f5b0000, v9
    v_subrev_f32 v27, 0x3f800000, v9
    v_cvt_pk_bf16_f32 v20, v20, v21
    v_and_b32 v21, v103, v20
    v_lshlrev_b32 v20, 16, v20
    v_cvt_pk_bf16_f32 v22, v22, v23
    v_and_b32 v23, v103, v22
    v_lshlrev_b32 v22, 16, v22
    v_cvt_pk_bf16_f32 v24, v24, v25
    v_and_b32 v25, v103, v24
    v_lshlrev_b32 v24, 16, v24
    v_cvt_pk_bf16_f32 v26, v26, v27
    v_and_b32 v27, v103, v26
    v_lshlrev_b32 v26, 16, v26
    v_mul_f32 v20, v20, v20
    v_mul_f32 v21, v21, v21
    v_mul_f32 v22, v22, v22
    v_mul_f32 v23, v23, v23
    v_mul_f32 v24, v24, v24
    v_mul_f32 v25, v25, v25
    v_mul_f32 v26, v26, v26
    v_mul_f32 v27, v27, v27
    v_cvt_pk_bf16_f32 v20, v20, v21
    v_and_b32 v21, v103, v20
    v_lshlrev_b32 v20, 16, v20
    v_cvt_pk_bf16_f32 v22, v22, v23
    v_and_b32 v23, v103, v22
    v_lshlrev_b32 v22, 16, v22
    v_cvt_pk_bf16_f32 v24, v24, v25
    v_and_b32 v25, v103, v24
    v_lshlrev_b32 v24, 16, v24
    v_cvt_pk_bf16_f32 v26, v26, v27
    v_and_b32 v27, v103, v26
    v_lshlrev_b32 v26, 16, v26
    v_mul_f32 v20, 0xc1200000, v20
    v_mul_f32 v21, 0xc1200000, v21
    v_mul_f32 v22, 0xc1200000, v22
    v_mul_f32 v23, 0xc1200000, v23
    v_mul_f32 v24, 0xc1200000, v24
    v_mul_f32 v25, 0xc1200000, v25
    v_mul_f32 v26, 0xc1200000, v26
    v_mul_f32 v27, 0xc1200000, v27
    v_cvt_pk_bf16_f32 v20, v20, v21
    v_and_b32 v21, v103, v20
    v_lshlrev_b32 v20, 16, v20
    v_cvt_pk_bf16_f32 v22, v22, v23
    v_and_b32 v23, v103, v22
    v_lshlrev_b32 v22, 16, v22
    v_cvt_pk_bf16_f32 v24, v24, v25
    v_and_b32 v25, v103, v24
    v_lshlrev_b32 v24, 16, v24
    v_cvt_pk_bf16_f32 v26, v26, v27
    v_and_b32 v27, v103, v26
    v_lshlrev_b32 v26, 16, v26
    v_mul_f32 v20, 0x3fb8aa3b, v20
    v_mul_f32 v21, 0x3fb8aa3b, v21
    v_mul_f32 v22, 0x3fb8aa3b, v22
    v_mul_f32 v23, 0x3fb8aa3b, v23
    v_mul_f32 v24, 0x3fb8aa3b, v24
    v_mul_f32 v25, 0x3fb8aa3b, v25
    v_mul_f32 v26, 0x3fb8aa3b, v26
    v_mul_f32 v27, 0x3fb8aa3b, v27
    v_exp_f32 v20, v20
    v_exp_f32 v21, v21
    v_exp_f32 v22, v22
    v_exp_f32 v23, v23
    v_exp_f32 v24, v24
    v_exp_f32 v25, v25
    v_exp_f32 v26, v26
    v_exp_f32 v27, v27
    s_nop 0
    v_cvt_pk_bf16_f32 v122, v20, v21
    v_cvt_pk_bf16_f32 v123, v22, v23
    v_cvt_pk_bf16_f32 v124, v24, v25
    v_cvt_pk_bf16_f32 v125, v26, v27
k2_e_116:
    s_cmp_lg_u32 s84, 15
    s_cbranch_scc1 k2_fw_nomid
    s_mov_b64 exec, 1
    s_waitcnt vmcnt(0)
    global_load_dword v78, v80, s[12:13] sc0 sc1
    s_mov_b64 exec, -1
k2_fw_nomid:
    v_dot2_f32_bf16 v106, v118, s40, 0
    v_dot2_f32_bf16 v107, v118, s42, 0
    v_dot2_f32_bf16 v108, v118, s41, 0
    v_dot2_f32_bf16 v109, v118, s43, 0
    v_dot2_f32_bf16 v106, v119, s44, v106
    v_dot2_f32_bf16 v107, v119, s46, v107
    v_dot2_f32_bf16 v108, v119, s45, v108
    v_dot2_f32_bf16 v109, v119, s47, v109
    v_dot2_f32_bf16 v106, v120, s48, v106
    v_dot2_f32_bf16 v107, v120, s50, v107
    v_dot2_f32_bf16 v108, v120, s49, v108
    v_dot2_f32_bf16 v109, v120, s51, v109
    v_dot2_f32_bf16 v106, v121, s52, v106
    v_dot2_f32_bf16 v107, v121, s54, v107
    v_dot2_f32_bf16 v108, v121, s53, v108
    v_dot2_f32_bf16 v109, v121, s55, v109
    s_cmp_ge_u32 s84, 4
    s_cbranch_scc1 k2_e_117
    v_dot2_f32_bf16 v110, v122, s40, 0
    v_dot2_f32_bf16 v111, v122, s42, 0
    v_dot2_f32_bf16 v112, v122, s41, 0
    v_dot2_f32_bf16 v113, v122, s43, 0
    v_dot2_f32_bf16 v110, v123, s44, v110
    v_dot2_f32_bf16 v111, v123, s46, v111
    v_dot2_f32_bf16 v112, v123, s45, v112
    v_dot2_f32_bf16 v113, v123, s47, v113
    v_dot2_f32_bf16 v110, v124, s48, v110
    v_dot2_f32_bf16 v111, v124, s50, v111
    v_dot2_f32_bf16 v112, v124, s49, v112
    v_dot2_f32_bf16 v113, v124, s51, v113
    v_dot2_f32_bf16 v110, v125, s52, v110
    v_dot2_f32_bf16 v111, v125, s54, v111
    v_dot2_f32_bf16 v112, v125, s53, v112
    v_dot2_f32_bf16 v113, v125, s55, v113
k2_e_117:
    v_dot2_f32_bf16 v88, v118, s56, 0
    v_dot2_f32_bf16 v89, v118, s58, 0
    v_dot2_f32_bf16 v90, v118, s57, 0
    v_dot2_f32_bf16 v91, v118, s59, 0
    v_dot2_f32_bf16 v88, v119, s60, v88
    v_dot2_f32_bf16 v89, v119, s62, v89
    v_dot2_f32_bf16 v90, v119, s61, v90
    v_dot2_f32_bf16 v91, v119, s63, v91
    v_dot2_f32_bf16 v88, v120, s64, v88
    v_dot2_f32_bf16 v89, v120, s66, v89
    v_dot2_f32_bf16 v90, v120, s65, v90
    v_dot2_f32_bf16 v91, v120, s67, v91
    v_dot2_f32_bf16 v88, v121, s68, v88
    v_dot2_f32_bf16 v89, v121, s70, v89
    v_dot2_f32_bf16 v90, v121, s69, v90
    v_dot2_f32_bf16 v91, v121, s71, v91
    s_nop 2
    v_cvt_pk_bf16_f32 v114, v88, v89
    v_cvt_pk_bf16_f32 v115, v90, v91
    s_cmp_ge_u32 s84, 4
    s_cbranch_scc1 k2_e_118
    v_dot2_f32_bf16 v88, v122, s56, 0
    v_dot2_f32_bf16 v89, v122, s58, 0
    v_dot2_f32_bf16 v90, v122, s57, 0
    v_dot2_f32_bf16 v91, v122, s59, 0
    v_dot2_f32_bf16 v88, v123, s60, v88
    v_dot2_f32_bf16 v89, v123, s62, v89
    v_dot2_f32_bf16 v90, v123, s61, v90
    v_dot2_f32_bf16 v91, v123, s63, v91
    v_dot2_f32_bf16 v88, v124, s64, v88
    v_dot2_f32_bf16 v89, v124, s66, v89
    v_dot2_f32_bf16 v90, v124, s65, v90
    v_dot2_f32_bf16 v91, v124, s67, v91
    v_dot2_f32_bf16 v88, v125, s68, v88
    v_dot2_f32_bf16 v89, v125, s70, v89
    v_dot2_f32_bf16 v90, v125, s69, v90
    v_dot2_f32_bf16 v91, v125, s71, v91
    s_nop 2
    v_cvt_pk_bf16_f32 v116, v88, v89
    v_cvt_pk_bf16_f32 v117, v90, v91
k2_e_118:
    s_load_dwordx16 s[48:63], s[18:19], 128
    s_load_dwordx8 s[64:71], s[18:19], 192
    s_waitcnt lgkmcnt(0)
    s_add_u32 s83, s83, 0xb000000
    v_mov_b32 v79, 155808
    s_cmp_lg_u32 s84, 15
    s_cbranch_scc1 k2_fw_done
    s_mov_b64 exec, 1
    s_mov_b32 s82, 0
    s_waitcnt vmcnt(0)
k2_fw_poll:
    s_nop 0
    v_readfirstlane_b32 s85, v78
    s_add_u32 s82, s82, 1
    s_nop 2
    s_and_b32 s81, s85, 0xff
    s_cmp_ge_u32 s81, 4
    s_cbranch_scc1 k2_fw_got
    s_cmp_lt_u32 s82, 0x40000
    s_cbranch_scc0 k2_fw_got
    global_load_dword v78, v80, s[12:13] sc0 sc1
    s_waitcnt vmcnt(0)
    s_branch k2_fw_poll
k2_fw_got:
    ds_write_b32 v79, v78
    s_waitcnt lgkmcnt(0)
    s_mov_b64 exec, -1
k2_fw_done:
    v_mov_b32 v86, 1250
    s_barrier
    ds_read_b32 v78, v79
    s_waitcnt lgkmcnt(0)
    v_readfirstlane_b32 s82, v78
    s_nop 3
    s_mov_b64 s[18:19], 0
    v_add_u32 v84, 0, v0
    v_lshlrev_b32 v85, 4, v84
    v_cmp_gt_u32 s[18:19], v86, v84
    s_mov_b64 exec, s[18:19]
    s_cbranch_execz k2_finz_119
    s_cmp_eq_u32 s86, 0
    s_cbranch_scc1 k2_q_120
    s_bitcmp1_b32 s82, 8
    s_cbranch_scc1 k2_q_121
    s_mov_b32 s91, 0
    buffer_load_dwordx2 v[28:29], v58, s[72:75], s91 offen sc0 sc1
    s_branch k2_q_120
k2_q_121:
    s_mov_b32 s91, 0
    buffer_load_dwordx4 v[28:31], v85, s[24:27], s91 offen sc0 sc1
k2_q_120:
    s_cmp_eq_u32 s86, 1
    s_cbranch_scc1 k2_q_122
    s_bitcmp1_b32 s82, 9
    s_cbranch_scc1 k2_q_123
    s_mov_b32 s91, 2560000
    buffer_load_dwordx2 v[32:33], v58, s[72:75], s91 offen sc0 sc1
    s_branch k2_q_122
k2_q_123:
    s_mov_b32 s91, 5120000
    buffer_load_dwordx4 v[32:35], v85, s[24:27], s91 offen sc0 sc1
k2_q_122:
    s_cmp_eq_u32 s86, 2
    s_cbranch_scc1 k2_q_124
    s_bitcmp1_b32 s82, 10
    s_cbranch_scc1 k2_q_125
    s_mov_b32 s91, 5120000
    buffer_load_dwordx2 v[36:37], v58, s[72:75], s91 offen sc0 sc1
    s_branch k2_q_124
k2_q_125:
    s_mov_b32 s91, 10240000
    buffer_load_dwordx4 v[36:39], v85, s[24:27], s91 offen sc0 sc1
k2_q_124:
    s_cmp_eq_u32 s86, 3
    s_cbranch_scc1 k2_q_126
    s_bitcmp1_b32 s82, 11
    s_cbranch_scc1 k2_q_127
    s_mov_b32 s91, 7680000
    buffer_load_dwordx2 v[40:41], v58, s[72:75], s91 offen sc0 sc1
    s_branch k2_q_126
k2_q_127:
    s_mov_b32 s91, 15360000
    buffer_load_dwordx4 v[40:43], v85, s[24:27], s91 offen sc0 sc1
k2_q_126:
k2_finz_119:
    s_mov_b64 exec, -1
    s_mov_b64 s[80:81], 0
    s_cmp_ge_u32 s84, 4
    s_cbranch_scc1 k2_finz_128
    v_add_u32 v84, 1024, v0
    v_lshlrev_b32 v85, 4, v84
    v_cmp_gt_u32 s[80:81], v86, v84
    s_mov_b64 exec, s[80:81]
    s_cbranch_execz k2_finz_128
    s_cmp_eq_u32 s86, 0
    s_cbranch_scc1 k2_q_129
    s_bitcmp1_b32 s82, 8
    s_cbranch_scc1 k2_q_130
    s_mov_b32 s91, 0
    buffer_load_dwordx2 v[4:5], v70, s[72:75], s91 offen sc0 sc1
    s_branch k2_q_129
k2_q_130:
    s_mov_b32 s91, 0
    buffer_load_dwordx4 v[4:7], v85, s[24:27], s91 offen sc0 sc1
k2_q_129:
    s_cmp_eq_u32 s86, 1
    s_cbranch_scc1 k2_q_131
    s_bitcmp1_b32 s82, 9
    s_cbranch_scc1 k2_q_132
    s_mov_b32 s91, 2560000
    buffer_load_dwordx2 v[8:9], v70, s[72:75], s91 offen sc0 sc1
    s_branch k2_q_131
k2_q_132:
    s_mov_b32 s91, 5120000
    buffer_load_dwordx4 v[8:11], v85, s[24:27], s91 offen sc0 sc1
k2_q_131:
    s_cmp_eq_u32 s86, 2
    s_cbranch_scc1 k2_q_133
    s_bitcmp1_b32 s82, 10
    s_cbranch_scc1 k2_q_134
    s_mov_b32 s91, 5120000
    buffer_load_dwordx2 v[12:13], v70, s[72:75], s91 offen sc0 sc1
    s_branch k2_q_133
k2_q_134:
    s_mov_b32 s91, 10240000
    buffer_load_dwordx4 v[12:15], v85, s[24:27], s91 offen sc0 sc1
k2_q_133:
    s_cmp_eq_u32 s86, 3
    s_cbranch_scc1 k2_q_135
    s_bitcmp1_b32 s82, 11
    s_cbranch_scc1 k2_q_136
    s_mov_b32 s91, 7680000
    buffer_load_dwordx2 v[16:17], v70, s[72:75], s91 offen sc0 sc1
    s_branch k2_q_135
k2_q_136:
    s_mov_b32 s91, 15360000
    buffer_load_dwordx4 v[16:19], v85, s[24:27], s91 offen sc0 sc1
k2_q_135:
k2_finz_128:
    s_mov_b64 exec, -1
    s_waitcnt vmcnt(0)
    s_mov_b64 exec, s[18:19]
    s_cbranch_execz k2_find_137
    s_cmp_eq_u32 s86, 0
    s_cbranch_scc1 k2_q_138
    s_bitcmp1_b32 s82, 8
    s_cbranch_scc1 k2_q_139
    v_fma_mix_f32 v52, v28, s83, v52 op_sel_hi:[1,0,0]
    v_fma_mix_f32 v53, v28, s83, v53 op_sel:[1,0,0] op_sel_hi:[1,0,0]
    v_fma_mix_f32 v54, v29, s83, v54 op_sel_hi:[1,0,0]
    v_fma_mix_f32 v55, v29, s83, v55 op_sel:[1,0,0] op_sel_hi:[1,0,0]
    s_branch k2_q_138
k2_q_139:
    v_add_f32 v52, v52, v28
    v_add_f32 v53, v53, v29
    v_add_f32 v54, v54, v30
    v_add_f32 v55, v55, v31
k2_q_138:
    s_cmp_eq_u32 s86, 1
    s_cbranch_scc1 k2_q_140
    s_bitcmp1_b32 s82, 9
    s_cbranch_scc1 k2_q_141
    v_fma_mix_f32 v52, v32, s83, v52 op_sel_hi:[1,0,0]
    v_fma_mix_f32 v53, v32, s83, v53 op_sel:[1,0,0] op_sel_hi:[1,0,0]
    v_fma_mix_f32 v54, v33, s83, v54 op_sel_hi:[1,0,0]
    v_fma_mix_f32 v55, v33, s83, v55 op_sel:[1,0,0] op_sel_hi:[1,0,0]
    s_branch k2_q_140
k2_q_141:
    v_add_f32 v52, v52, v32
    v_add_f32 v53, v53, v33
    v_add_f32 v54, v54, v34
    v_add_f32 v55, v55, v35
k2_q_140:
    s_cmp_eq_u32 s86, 2
    s_cbranch_scc1 k2_q_142
    s_bitcmp1_b32 s82, 10
    s_cbranch_scc1 k2_q_143
    v_fma_mix_f32 v52, v36, s83, v52 op_sel_hi:[1,0,0]
    v_fma_mix_f32 v53, v36, s83, v53 op_sel:[1,0,0] op_sel_hi:[1,0,0]
    v_fma_mix_f32 v54, v37, s83, v54 op_sel_hi:[1,0,0]
    v_fma_mix_f32 v55, v37, s83, v55 op_sel:[1,0,0] op_sel_hi:[1,0,0]
    s_branch k2_q_142
k2_q_143:
    v_add_f32 v52, v52, v36
    v_add_f32 v53, v53, v37
    v_add_f32 v54, v54, v38
    v_add_f32 v55, v55, v39
k2_q_142:
    s_cmp_eq_u32 s86, 3
    s_cbranch_scc1 k2_q_144
    s_bitcmp1_b32 s82, 11
    s_cbranch_scc1 k2_q_145
    v_fma_mix_f32 v52, v40, s83, v52 op_sel_hi:[1,0,0]
    v_fma_mix_f32 v53, v40, s83, v53 op_sel:[1,0,0] op_sel_hi:[1,0,0]
    v_fma_mix_f32 v54, v41, s83, v54 op_sel_hi:[1,0,0]
    v_fma_mix_f32 v55, v41, s83, v55 op_sel:[1,0,0] op_sel_hi:[1,0,0]
    s_branch k2_q_144
k2_q_145:
    v_add_f32 v52, v52, v40
    v_add_f32 v53, v53, v41
    v_add_f32 v54, v54, v42
    v_add_f32 v55, v55, v43
k2_q_144:
    v_mul_f32 v88, s48, v52
    v_mul_f32 v89, s49, v52
    v_mul_f32 v90, s50, v52
    v_mul_f32 v91, s51, v52
    v_fmac_f32 v88, s52, v53
    v_fmac_f32 v89, s53, v53
    v_fmac_f32 v90, s54, v53
    v_fmac_f32 v91, s55, v53
    v_fmac_f32 v88, s56, v54
    v_fmac_f32 v89, s57, v54
    v_fmac_f32 v90, s58, v54
    v_fmac_f32 v91, s59, v54
    v_fmac_f32 v88, s60, v55
    v_fmac_f32 v89, s61, v55
    v_fmac_f32 v90, s62, v55
    v_fmac_f32 v91, s63, v55
    v_mul_f32 v88, v88, v106
    v_mul_f32 v89, v89, v107
    v_mul_f32 v90, v90, v108
    v_mul_f32 v91, v91, v109
    v_cvt_pk_bf16_f32 v88, v88, v89
    v_cvt_pk_bf16_f32 v89, v90, v91
    v_lshlrev_b32 v76, 16, v114
    v_and_b32 v77, v103, v114
    v_lshlrev_b32 v78, 16, v115
    v_and_b32 v79, v103, v115
    v_dot2_f32_bf16 v92, v88, s64, 0
    v_dot2_f32_bf16 v93, v88, s66, 0
    v_dot2_f32_bf16 v94, v88, s65, 0
    v_dot2_f32_bf16 v95, v88, s67, 0
    v_dot2_f32_bf16 v92, v89, s68, v92
    v_dot2_f32_bf16 v93, v89, s70, v93
    v_dot2_f32_bf16 v94, v89, s69, v94
    v_dot2_f32_bf16 v95, v89, s71, v95
    s_nop 2
    v_cvt_pk_bf16_f32 v92, v92, v93
    v_and_b32 v93, v103, v92
    v_lshlrev_b32 v92, 16, v92
    v_cvt_pk_bf16_f32 v94, v94, v95
    v_and_b32 v95, v103, v94
    v_lshlrev_b32 v94, 16, v94
    v_mul_f32 v92, v92, v76
    v_mul_f32 v93, v93, v77
    v_mul_f32 v94, v94, v78
    v_mul_f32 v95, v95, v79
    v_cvt_pk_bf16_f32 v92, v92, v93
    v_and_b32 v93, v103, v92
    v_lshlrev_b32 v92, 16, v92
    v_cvt_pk_bf16_f32 v94, v94, v95
    v_and_b32 v95, v103, v94
    v_lshlrev_b32 v94, 16, v94
    v_lshlrev_b32 v88, 16, v56
    v_and_b32 v89, v103, v56
    v_lshlrev_b32 v90, 16, v57
    v_and_b32 v91, v103, v57
    v_add_f32 v88, v88, v92
    v_add_f32 v89, v89, v93
    v_add_f32 v90, v90, v94
    v_add_f32 v91, v91, v95
    v_cvt_pk_bf16_f32 v88, v88, v89
    v_cvt_pk_bf16_f32 v89, v90, v91
    buffer_store_dwordx2 v[88:89], v58, s[20:23], 0 offen
k2_find_137:
    s_mov_b64 exec, -1
    s_mov_b64 exec, s[80:81]
    s_cbranch_execz k2_find_146
    s_cmp_eq_u32 s86, 0
    s_cbranch_scc1 k2_q_147
    s_bitcmp1_b32 s82, 8
    s_cbranch_scc1 k2_q_148
    v_fma_mix_f32 v60, v4, s83, v60 op_sel_hi:[1,0,0]
    v_fma_mix_f32 v61, v4, s83, v61 op_sel:[1,0,0] op_sel_hi:[1,0,0]
    v_fma_mix_f32 v62, v5, s83, v62 op_sel_hi:[1,0,0]
    v_fma_mix_f32 v63, v5, s83, v63 op_sel:[1,0,0] op_sel_hi:[1,0,0]
    s_branch k2_q_147
k2_q_148:
    v_add_f32 v60, v60, v4
    v_add_f32 v61, v61, v5
    v_add_f32 v62, v62, v6
    v_add_f32 v63, v63, v7
k2_q_147:
    s_cmp_eq_u32 s86, 1
    s_cbranch_scc1 k2_q_149
    s_bitcmp1_b32 s82, 9
    s_cbranch_scc1 k2_q_150
    v_fma_mix_f32 v60, v8, s83, v60 op_sel_hi:[1,0,0]
    v_fma_mix_f32 v61, v8, s83, v61 op_sel:[1,0,0] op_sel_hi:[1,0,0]
    v_fma_mix_f32 v62, v9, s83, v62 op_sel_hi:[1,0,0]
    v_fma_mix_f32 v63, v9, s83, v63 op_sel:[1,0,0] op_sel_hi:[1,0,0]
    s_branch k2_q_149
k2_q_150:
    v_add_f32 v60, v60, v8
    v_add_f32 v61, v61, v9
    v_add_f32 v62, v62, v10
    v_add_f32 v63, v63, v11
k2_q_149:
    s_cmp_eq_u32 s86, 2
    s_cbranch_scc1 k2_q_151
    s_bitcmp1_b32 s82, 10
    s_cbranch_scc1 k2_q_152
    v_fma_mix_f32 v60, v12, s83, v60 op_sel_hi:[1,0,0]
    v_fma_mix_f32 v61, v12, s83, v61 op_sel:[1,0,0] op_sel_hi:[1,0,0]
    v_fma_mix_f32 v62, v13, s83, v62 op_sel_hi:[1,0,0]
    v_fma_mix_f32 v63, v13, s83, v63 op_sel:[1,0,0] op_sel_hi:[1,0,0]
    s_branch k2_q_151
k2_q_152:
    v_add_f32 v60, v60, v12
    v_add_f32 v61, v61, v13
    v_add_f32 v62, v62, v14
    v_add_f32 v63, v63, v15
k2_q_151:
    s_cmp_eq_u32 s86, 3
    s_cbranch_scc1 k2_q_153
    s_bitcmp1_b32 s82, 11
    s_cbranch_scc1 k2_q_154
    v_fma_mix_f32 v60, v16, s83, v60 op_sel_hi:[1,0,0]
    v_fma_mix_f32 v61, v16, s83, v61 op_sel:[1,0,0] op_sel_hi:[1,0,0]
    v_fma_mix_f32 v62, v17, s83, v62 op_sel_hi:[1,0,0]
    v_fma_mix_f32 v63, v17, s83, v63 op_sel:[1,0,0] op_sel_hi:[1,0,0]
    s_branch k2_q_153
k2_q_154:
    v_add_f32 v60, v60, v16
    v_add_f32 v61, v61, v17
    v_add_f32 v62, v62, v18
    v_add_f32 v63, v63, v19
k2_q_153:
    v_mul_f32 v88, s48, v60
    v_mul_f32 v89, s49, v60
    v_mul_f32 v90, s50, v60
    v_mul_f32 v91, s51, v60
    v_fmac_f32 v88, s52, v61
    v_fmac_f32 v89, s53, v61
    v_fmac_f32 v90, s54, v61
    v_fmac_f32 v91, s55, v61
    v_fmac_f32 v88, s56, v62
    v_fmac_f32 v89, s57, v62
    v_fmac_f32 v90, s58, v62
    v_fmac_f32 v91, s59, v62
    v_fmac_f32 v88, s60, v63
    v_fmac_f32 v89, s61, v63
    v_fmac_f32 v90, s62, v63
    v_fmac_f32 v91, s63, v63
    v_mul_f32 v88, v88, v110
    v_mul_f32 v89, v89, v111
    v_mul_f32 v90, v90, v112
    v_mul_f32 v91, v91, v113
    v_cvt_pk_bf16_f32 v88, v88, v89
    v_cvt_pk_bf16_f32 v89, v90, v91
    v_lshlrev_b32 v76, 16, v116
    v_and_b32 v77, v103, v116
    v_lshlrev_b32 v78, 16, v117
    v_and_b32 v79, v103, v117
    v_dot2_f32_bf16 v92, v88, s64, 0
    v_dot2_f32_bf16 v93, v88, s66, 0
    v_dot2_f32_bf16 v94, v88, s65, 0
    v_dot2_f32_bf16 v95, v88, s67, 0
    v_dot2_f32_bf16 v92, v89, s68, v92
    v_dot2_f32_bf16 v93, v89, s70, v93
    v_dot2_f32_bf16 v94, v89, s69, v94
    v_dot2_f32_bf16 v95, v89, s71, v95
    s_nop 2
    v_cvt_pk_bf16_f32 v92, v92, v93
    v_and_b32 v93, v103, v92
    v_lshlrev_b32 v92, 16, v92
    v_cvt_pk_bf16_f32 v94, v94, v95
    v_and_b32 v95, v103, v94
    v_lshlrev_b32 v94, 16, v94
    v_mul_f32 v92, v92, v76
    v_mul_f32 v93, v93, v77
    v_mul_f32 v94, v94, v78
    v_mul_f32 v95, v95, v79
    v_cvt_pk_bf16_f32 v92, v92, v93
    v_and_b32 v93, v103, v92
    v_lshlrev_b32 v92, 16, v92
    v_cvt_pk_bf16_f32 v94, v94, v95
    v_and_b32 v95, v103, v94
    v_lshlrev_b32 v94, 16, v94
    v_lshlrev_b32 v88, 16, v68
    v_and_b32 v89, v103, v68
    v_lshlrev_b32 v90, 16, v69
    v_and_b32 v91, v103, v69
    v_add_f32 v88, v88, v92
    v_add_f32 v89, v89, v93
    v_add_f32 v90, v90, v94
    v_add_f32 v91, v91, v95
    v_cvt_pk_bf16_f32 v88, v88, v89
    v_cvt_pk_bf16_f32 v89, v90, v91
    buffer_store_dwordx2 v[88:89], v70, s[20:23], 0 offen
k2_find_146:
    s_mov_b64 exec, -1
    s_branch k2_end
k2_slowb:
    s_barrier
    v_mov_b32 v88, 155792
    ds_read_b96 v[84:86], v88
    s_waitcnt lgkmcnt(0)
    v_readfirstlane_b32 s83, v85
k2_slow:
    s_mov_b32 s89, 1
    s_waitcnt vmcnt(0) lgkmcnt(0)
    s_barrier
    s_mul_i32 s14, s87, 5000
    s_mul_i32 s15, s86, 1250
    s_add_u32 s14, s14, s15
    s_lshl_b32 s15, s14, 1
    s_add_u32 s60, s8, s15
    s_addc_u32 s61, s9, 0
    s_and_b32 s61, s61, 0xffff
    s_mov_b32 s62, 2500
    s_mov_b32 s63, 0x20000
    v_add_u32 v81, 0, v0
    v_lshlrev_b32 v81, 1, v81
    buffer_load_ushort v5, v81, s[60:63], 0 offen
    v_add_u32 v81, 1024, v0
    v_lshlrev_b32 v81, 1, v81
    buffer_load_ushort v9, v81, s[60:63], 0 offen
    s_waitcnt vmcnt(0) lgkmcnt(0)
    v_mov_b32 v80, 0
    v_mov_b32 v81, 0
    v_mov_b32 v82, 0
    v_mov_b32 v83, 0
    ds_write_b128 v1, v[80:83] offset:0
    ds_write_b128 v1, v[80:83] offset:16384
    ds_write_b128 v1, v[80:83] offset:32768
    ds_write_b128 v1, v[80:83] offset:49152
    v_add_u32 v78, 0x10000, v1
    v_cmp_gt_u32 vcc, 904, v0
    s_and_saveexec_b64 s[80:81], vcc
    ds_write_b128 v78, v[80:83]
    s_mov_b64 exec, s[80:81]
    s_waitcnt vmcnt(0) lgkmcnt(0)
    s_barrier
    s_lshl_b32 s90, s84, 10
    s_mul_i32 s91, s86, 53760
    s_add_u32 m0, s90, 80000
    s_add_u32 s92, s91, 0
    buffer_load_dwordx4 v1, s[20:23], s92 offen lds
    s_add_u32 m0, s90, 96384
    s_add_u32 s92, s91, 16384
    buffer_load_dwordx4 v1, s[20:23], s92 offen lds
    s_add_u32 m0, s90, 112768
    s_add_u32 s92, s91, 32768
    buffer_load_dwordx4 v1, s[20:23], s92 offen lds
    s_cmp_ge_u32 s84, 5
    s_cbranch_scc1 k2_fill_157
    s_add_u32 m0, s90, 129152
    s_add_u32 s92, s91, 49152
    buffer_load_dwordx4 v1, s[20:23], s92 offen lds
k2_fill_157:
    s_mov_b32 s85, 0
k2_sw_155:
    s_cmp_ge_u32 s85, s64
    s_cbranch_scc1 k2_se_156
    s_mov_b32 exec_lo, 0xffff
    s_mov_b32 exec_hi, 0x0
    v_lshrrev_b32 v96, 16, v2
    v_and_b32 v94, 0xffff, v2
    v_lshl_add_u32 v94, v94, 2, v19
    v_subrev_u32 v95, s85, v6
    v_lshlrev_b32 v95, 2, v95
k2_smap_158:
    v_cmpx_lt_i32 vcc, 0, v96
    s_cbranch_execz k2_smapd_159
    v_min_u32 v93, 4, v96
    v_add3_u32 v93, v93, v94, -1
    s_mov_b64 s[80:81], exec
    v_mov_b32 v97, 4096
    v_cmpx_lt_u32 vcc, v95, v97
    v_add_u32 v98, 134272, v95
    ds_write_b32 v98, v93
    s_mov_b64 exec, s[80:81]
    v_add_u32 v94, 16, v94
    v_add_u32 v95, 4, v95
    v_add_u32 v96, -4, v96
    s_branch k2_smap_158
k2_smapd_159:
    s_mov_b64 exec, -1
    s_waitcnt vmcnt(0) lgkmcnt(0)
    s_barrier
    s_mov_b32 s82, s64
    s_sub_u32 s64, s64, s85
    v_cmp_gt_u32 s[40:41], s64, v0
    v_add_u32 v91, 134272, v102
    ds_read_b32 v34, v91
    s_waitcnt lgkmcnt(0)
    s_mov_b64 s[42:43], 0
    s_mov_b64 s[44:45], 0
    s_mov_b64 s[46:47], 0
    s_mov_b64 exec, s[40:41]
    s_cbranch_execz k2_lr_160
    v_and_b32 v35, -4, v34
    buffer_load_dwordx4 v[28:31], v35, s[24:27], 0 offen
    v_lshrrev_b32 v35, 1, v35
    buffer_load_dwordx2 v[32:33], v35, s[76:79], 0 offen
    v_and_b32 v34, 3, v34
    v_cmp_le_u32 s[42:43], 1, v34
    v_cmp_le_u32 s[44:45], 2, v34
    v_cmp_le_u32 s[46:47], 3, v34
k2_lr_160:
    s_mov_b64 exec, -1
    s_mov_b32 s64, s82
    s_waitcnt vmcnt(0) lgkmcnt(0)
    v_mad_u32_u16 v76, v28, 1, v101
    v_mad_u32_u16 v77, v29, 1, v101
    v_mad_u32_u16 v78, v30, 1, v101
    v_mad_u32_u16 v79, v31, 1, v101
    s_mov_b64 exec, s[40:41]
    ds_read_b64 v[52:53], v76
    s_mov_b64 exec, s[42:43]
    ds_read_b64 v[54:55], v77
    s_mov_b64 exec, s[44:45]
    ds_read_b64 v[56:57], v78
    s_mov_b64 exec, s[46:47]
    ds_read_b64 v[58:59], v79
    s_mov_b64 exec, -1
    s_waitcnt lgkmcnt(0)
    v_lshlrev_b32 v80, 16, v32
    v_lshlrev_b32 v60, 16, v52
    v_and_b32 v61, v103, v52
    v_lshlrev_b32 v62, 16, v53
    v_and_b32 v63, v103, v53
    v_mul_f32 v60, v80, v60
    v_mul_f32 v61, v80, v61
    v_mul_f32 v62, v80, v62
    v_mul_f32 v63, v80, v63
    v_lshrrev_b32 v84, 16, v28
    s_mov_b64 exec, s[40:41]
    ds_add_f32 v84, v60
    ds_add_f32 v84, v61 offset:4
    ds_add_f32 v84, v62 offset:40000
    ds_add_f32 v84, v63 offset:40004
    s_mov_b64 exec, -1
    v_and_b32 v81, v103, v32
    v_lshlrev_b32 v64, 16, v54
    v_and_b32 v65, v103, v54
    v_lshlrev_b32 v66, 16, v55
    v_and_b32 v67, v103, v55
    v_mul_f32 v64, v81, v64
    v_mul_f32 v65, v81, v65
    v_mul_f32 v66, v81, v66
    v_mul_f32 v67, v81, v67
    v_lshrrev_b32 v85, 16, v29
    s_mov_b64 exec, s[42:43]
    ds_add_f32 v85, v64
    ds_add_f32 v85, v65 offset:4
    ds_add_f32 v85, v66 offset:40000
    ds_add_f32 v85, v67 offset:40004
    s_mov_b64 exec, -1
    v_lshlrev_b32 v82, 16, v33
    v_lshlrev_b32 v68, 16, v56
    v_and_b32 v69, v103, v56
    v_lshlrev_b32 v70, 16, v57
    v_and_b32 v71, v103, v57
    v_mul_f32 v68, v82, v68
    v_mul_f32 v69, v82, v69
    v_mul_f32 v70, v82, v70
    v_mul_f32 v71, v82, v71
    v_lshrrev_b32 v86, 16, v30
    s_mov_b64 exec, s[44:45]
    ds_add_f32 v86, v68
    ds_add_f32 v86, v69 offset:4
    ds_add_f32 v86, v70 offset:40000
    ds_add_f32 v86, v71 offset:40004
    s_mov_b64 exec, -1
    v_and_b32 v83, v103, v33
    v_lshlrev_b32 v72, 16, v58
    v_and_b32 v73, v103, v58
    v_lshlrev_b32 v74, 16, v59
    v_and_b32 v75, v103, v59
    v_mul_f32 v72, v83, v72
    v_mul_f32 v73, v83, v73
    v_mul_f32 v74, v83, v74
    v_mul_f32 v75, v83, v75
    v_lshrrev_b32 v87, 16, v31
    s_mov_b64 exec, s[46:47]
    ds_add_f32 v87, v72
    ds_add_f32 v87, v73 offset:4
    ds_add_f32 v87, v74 offset:40000
    ds_add_f32 v87, v75 offset:40004
    s_mov_b64 exec, -1
    s_waitcnt lgkmcnt(0)
    s_barrier
    s_add_u32 s85, s85, 1024
    s_branch k2_sw_155
k2_se_156:
    s_waitcnt vmcnt(0) lgkmcnt(0)
    s_barrier
    s_lshl_b32 s90, s84, 10
    s_mul_i32 s91, s86, 53760
    s_add_u32 m0, s90, 80000
    s_add_u32 s92, s91, 215040
    buffer_load_dwordx4 v1, s[20:23], s92 offen lds
    s_add_u32 m0, s90, 96384
    s_add_u32 s92, s91, 231424
    buffer_load_dwordx4 v1, s[20:23], s92 offen lds
    s_add_u32 m0, s90, 112768
    s_add_u32 s92, s91, 247808
    buffer_load_dwordx4 v1, s[20:23], s92 offen lds
    s_cmp_ge_u32 s84, 5
    s_cbranch_scc1 k2_fill_163
    s_add_u32 m0, s90, 129152
    s_add_u32 s92, s91, 264192
    buffer_load_dwordx4 v1, s[20:23], s92 offen lds
k2_fill_163:
    s_mov_b32 s85, 0
k2_sw_161:
    s_cmp_ge_u32 s85, s65
    s_cbranch_scc1 k2_se_162
    s_mov_b32 exec_lo, 0xffff
    s_mov_b32 exec_hi, 0x0
    v_lshrrev_b32 v96, 16, v3
    v_and_b32 v94, 0xffff, v3
    v_lshl_add_u32 v94, v94, 2, v19
    v_subrev_u32 v95, s85, v7
    v_lshlrev_b32 v95, 2, v95
k2_smap_164:
    v_cmpx_lt_i32 vcc, 0, v96
    s_cbranch_execz k2_smapd_165
    v_min_u32 v93, 4, v96
    v_add3_u32 v93, v93, v94, -1
    s_mov_b64 s[80:81], exec
    v_mov_b32 v97, 4096
    v_cmpx_lt_u32 vcc, v95, v97
    v_add_u32 v98, 134272, v95
    ds_write_b32 v98, v93
    s_mov_b64 exec, s[80:81]
    v_add_u32 v94, 16, v94
    v_add_u32 v95, 4, v95
    v_add_u32 v96, -4, v96
    s_branch k2_smap_164
k2_smapd_165:
    s_mov_b64 exec, -1
    s_waitcnt vmcnt(0) lgkmcnt(0)
    s_barrier
    s_mov_b32 s82, s65
    s_sub_u32 s65, s65, s85
    v_cmp_gt_u32 s[40:41], s65, v0
    v_add_u32 v91, 134272, v102
    ds_read_b32 v34, v91
    s_waitcnt lgkmcnt(0)
    s_mov_b64 s[42:43], 0
    s_mov_b64 s[44:45], 0
    s_mov_b64 s[46:47], 0
    s_mov_b64 exec, s[40:41]
    s_cbranch_execz k2_lr_166
    v_and_b32 v35, -4, v34
    buffer_load_dwordx4 v[28:31], v35, s[24:27], 0 offen
    v_lshrrev_b32 v35, 1, v35
    buffer_load_dwordx2 v[32:33], v35, s[76:79], 0 offen
    v_and_b32 v34, 3, v34
    v_cmp_le_u32 s[42:43], 1, v34
    v_cmp_le_u32 s[44:45], 2, v34
    v_cmp_le_u32 s[46:47], 3, v34
k2_lr_166:
    s_mov_b64 exec, -1
    s_mov_b32 s65, s82
    s_waitcnt vmcnt(0) lgkmcnt(0)
    v_mad_u32_u16 v76, v28, 1, v101
    v_mad_u32_u16 v77, v29, 1, v101
    v_mad_u32_u16 v78, v30, 1, v101
    v_mad_u32_u16 v79, v31, 1, v101
    s_mov_b64 exec, s[40:41]
    ds_read_b64 v[52:53], v76
    s_mov_b64 exec, s[42:43]
    ds_read_b64 v[54:55], v77
    s_mov_b64 exec, s[44:45]
    ds_read_b64 v[56:57], v78
    s_mov_b64 exec, s[46:47]
    ds_read_b64 v[58:59], v79
    s_mov_b64 exec, -1
    s_waitcnt lgkmcnt(0)
    v_lshlrev_b32 v80, 16, v32
    v_lshlrev_b32 v60, 16, v52
    v_and_b32 v61, v103, v52
    v_lshlrev_b32 v62, 16, v53
    v_and_b32 v63, v103, v53
    v_mul_f32 v60, v80, v60
    v_mul_f32 v61, v80, v61
    v_mul_f32 v62, v80, v62
    v_mul_f32 v63, v80, v63
    v_lshrrev_b32 v84, 16, v28
    s_mov_b64 exec, s[40:41]
    ds_add_f32 v84, v60
    ds_add_f32 v84, v61 offset:4
    ds_add_f32 v84, v62 offset:40000
    ds_add_f32 v84, v63 offset:40004
    s_mov_b64 exec, -1
    v_and_b32 v81, v103, v32
    v_lshlrev_b32 v64, 16, v54
    v_and_b32 v65, v103, v54
    v_lshlrev_b32 v66, 16, v55
    v_and_b32 v67, v103, v55
    v_mul_f32 v64, v81, v64
    v_mul_f32 v65, v81, v65
    v_mul_f32 v66, v81, v66
    v_mul_f32 v67, v81, v67
    v_lshrrev_b32 v85, 16, v29
    s_mov_b64 exec, s[42:43]
    ds_add_f32 v85, v64
    ds_add_f32 v85, v65 offset:4
    ds_add_f32 v85, v66 offset:40000
    ds_add_f32 v85, v67 offset:40004
    s_mov_b64 exec, -1
    v_lshlrev_b32 v82, 16, v33
    v_lshlrev_b32 v68, 16, v56
    v_and_b32 v69, v103, v56
    v_lshlrev_b32 v70, 16, v57
    v_and_b32 v71, v103, v57
    v_mul_f32 v68, v82, v68
    v_mul_f32 v69, v82, v69
    v_mul_f32 v70, v82, v70
    v_mul_f32 v71, v82, v71
    v_lshrrev_b32 v86, 16, v30
    s_mov_b64 exec, s[44:45]
    ds_add_f32 v86, v68
    ds_add_f32 v86, v69 offset:4
    ds_add_f32 v86, v70 offset:40000
    ds_add_f32 v86, v71 offset:40004
    s_mov_b64 exec, -1
    v_and_b32 v83, v103, v33
    v_lshlrev_b32 v72, 16, v58
    v_and_b32 v73, v103, v58
    v_lshlrev_b32 v74, 16, v59
    v_and_b32 v75, v103, v59
    v_mul_f32 v72, v83, v72
    v_mul_f32 v73, v83, v73
    v_mul_f32 v74, v83, v74
    v_mul_f32 v75, v83, v75
    v_lshrrev_b32 v87, 16, v31
    s_mov_b64 exec, s[46:47]
    ds_add_f32 v87, v72
    ds_add_f32 v87, v73 offset:4
    ds_add_f32 v87, v74 offset:40000
    ds_add_f32 v87, v75 offset:40004
    s_mov_b64 exec, -1
    s_waitcnt lgkmcnt(0)
    s_barrier
    s_add_u32 s85, s85, 1024
    s_branch k2_sw_161
k2_se_162:
    s_waitcnt vmcnt(0) lgkmcnt(0)
    s_barrier
    s_lshl_b32 s90, s84, 10
    s_mul_i32 s91, s86, 53760
    s_add_u32 m0, s90, 80000
    s_add_u32 s92, s91, 430080
    buffer_load_dwordx4 v1, s[20:23], s92 offen lds
    s_add_u32 m0, s90, 96384
    s_add_u32 s92, s91, 446464
    buffer_load_dwordx4 v1, s[20:23], s92 offen lds
    s_add_u32 m0, s90, 112768
    s_add_u32 s92, s91, 462848
    buffer_load_dwordx4 v1, s[20:23], s92 offen lds
    s_cmp_ge_u32 s84, 5
    s_cbranch_scc1 k2_fill_169
    s_add_u32 m0, s90, 129152
    s_add_u32 s92, s91, 479232
    buffer_load_dwordx4 v1, s[20:23], s92 offen lds
k2_fill_169:
    s_mov_b32 s85, 0
k2_sw_167:
    s_cmp_ge_u32 s85, s66
    s_cbranch_scc1 k2_se_168
    s_mov_b32 exec_lo, 0xffff
    s_mov_b32 exec_hi, 0x0
    v_lshrrev_b32 v96, 16, v4
    v_and_b32 v94, 0xffff, v4
    v_lshl_add_u32 v94, v94, 2, v19
    v_subrev_u32 v95, s85, v8
    v_lshlrev_b32 v95, 2, v95
k2_smap_170:
    v_cmpx_lt_i32 vcc, 0, v96
    s_cbranch_execz k2_smapd_171
    v_min_u32 v93, 4, v96
    v_add3_u32 v93, v93, v94, -1
    s_mov_b64 s[80:81], exec
    v_mov_b32 v97, 4096
    v_cmpx_lt_u32 vcc, v95, v97
    v_add_u32 v98, 134272, v95
    ds_write_b32 v98, v93
    s_mov_b64 exec, s[80:81]
    v_add_u32 v94, 16, v94
    v_add_u32 v95, 4, v95
    v_add_u32 v96, -4, v96
    s_branch k2_smap_170
k2_smapd_171:
    s_mov_b64 exec, -1
    s_waitcnt vmcnt(0) lgkmcnt(0)
    s_barrier
    s_mov_b32 s82, s66
    s_sub_u32 s66, s66, s85
    v_cmp_gt_u32 s[40:41], s66, v0
    v_add_u32 v91, 134272, v102
    ds_read_b32 v34, v91
    s_waitcnt lgkmcnt(0)
    s_mov_b64 s[42:43], 0
    s_mov_b64 s[44:45], 0
    s_mov_b64 s[46:47], 0
    s_mov_b64 exec, s[40:41]
    s_cbranch_execz k2_lr_172
    v_and_b32 v35, -4, v34
    buffer_load_dwordx4 v[28:31], v35, s[24:27], 0 offen
    v_lshrrev_b32 v35, 1, v35
    buffer_load_dwordx2 v[32:33], v35, s[76:79], 0 offen
    v_and_b32 v34, 3, v34
    v_cmp_le_u32 s[42:43], 1, v34
    v_cmp_le_u32 s[44:45], 2, v34
    v_cmp_le_u32 s[46:47], 3, v34
k2_lr_172:
    s_mov_b64 exec, -1
    s_mov_b32 s66, s82
    s_waitcnt vmcnt(0) lgkmcnt(0)
    v_mad_u32_u16 v76, v28, 1, v101
    v_mad_u32_u16 v77, v29, 1, v101
    v_mad_u32_u16 v78, v30, 1, v101
    v_mad_u32_u16 v79, v31, 1, v101
    s_mov_b64 exec, s[40:41]
    ds_read_b64 v[52:53], v76
    s_mov_b64 exec, s[42:43]
    ds_read_b64 v[54:55], v77
    s_mov_b64 exec, s[44:45]
    ds_read_b64 v[56:57], v78
    s_mov_b64 exec, s[46:47]
    ds_read_b64 v[58:59], v79
    s_mov_b64 exec, -1
    s_waitcnt lgkmcnt(0)
    v_lshlrev_b32 v80, 16, v32
    v_lshlrev_b32 v60, 16, v52
    v_and_b32 v61, v103, v52
    v_lshlrev_b32 v62, 16, v53
    v_and_b32 v63, v103, v53
    v_mul_f32 v60, v80, v60
    v_mul_f32 v61, v80, v61
    v_mul_f32 v62, v80, v62
    v_mul_f32 v63, v80, v63
    v_lshrrev_b32 v84, 16, v28
    s_mov_b64 exec, s[40:41]
    ds_add_f32 v84, v60
    ds_add_f32 v84, v61 offset:4
    ds_add_f32 v84, v62 offset:40000
    ds_add_f32 v84, v63 offset:40004
    s_mov_b64 exec, -1
    v_and_b32 v81, v103, v32
    v_lshlrev_b32 v64, 16, v54
    v_and_b32 v65, v103, v54
    v_lshlrev_b32 v66, 16, v55
    v_and_b32 v67, v103, v55
    v_mul_f32 v64, v81, v64
    v_mul_f32 v65, v81, v65
    v_mul_f32 v66, v81, v66
    v_mul_f32 v67, v81, v67
    v_lshrrev_b32 v85, 16, v29
    s_mov_b64 exec, s[42:43]
    ds_add_f32 v85, v64
    ds_add_f32 v85, v65 offset:4
    ds_add_f32 v85, v66 offset:40000
    ds_add_f32 v85, v67 offset:40004
    s_mov_b64 exec, -1
    v_lshlrev_b32 v82, 16, v33
    v_lshlrev_b32 v68, 16, v56
    v_and_b32 v69, v103, v56
    v_lshlrev_b32 v70, 16, v57
    v_and_b32 v71, v103, v57
    v_mul_f32 v68, v82, v68
    v_mul_f32 v69, v82, v69
    v_mul_f32 v70, v82, v70
    v_mul_f32 v71, v82, v71
    v_lshrrev_b32 v86, 16, v30
    s_mov_b64 exec, s[44:45]
    ds_add_f32 v86, v68
    ds_add_f32 v86, v69 offset:4
    ds_add_f32 v86, v70 offset:40000
    ds_add_f32 v86, v71 offset:40004
    s_mov_b64 exec, -1
    v_and_b32 v83, v103, v33
    v_lshlrev_b32 v72, 16, v58
    v_and_b32 v73, v103, v58
    v_lshlrev_b32 v74, 16, v59
    v_and_b32 v75, v103, v59
    v_mul_f32 v72, v83, v72
    v_mul_f32 v73, v83, v73
    v_mul_f32 v74, v83, v74
    v_mul_f32 v75, v83, v75
    v_lshrrev_b32 v87, 16, v31
    s_mov_b64 exec, s[46:47]
    ds_add_f32 v87, v72
    ds_add_f32 v87, v73 offset:4
    ds_add_f32 v87, v74 offset:40000
    ds_add_f32 v87, v75 offset:40004
    s_mov_b64 exec, -1
    s_waitcnt lgkmcnt(0)
    s_barrier
    s_add_u32 s85, s85, 1024
    s_branch k2_sw_167
k2_se_168:
    s_waitcnt vmcnt(0) lgkmcnt(0)
    s_barrier
    s_lshl_b32 s90, s84, 10
    s_mul_i32 s91, s86, 53760
    s_add_u32 m0, s90, 80000
    s_add_u32 s92, s91, 645120
    buffer_load_dwordx4 v1, s[20:23], s92 offen lds
    s_add_u32 m0, s90, 96384
    s_add_u32 s92, s91, 661504
    buffer_load_dwordx4 v1, s[20:23], s92 offen lds
    s_add_u32 m0, s90, 112768
    s_add_u32 s92, s91, 677888
    buffer_load_dwordx4 v1, s[20:23], s92 offen lds
    s_cmp_ge_u32 s84, 5
    s_cbranch_scc1 k2_fill_175
    s_add_u32 m0, s90, 129152
    s_add_u32 s92, s91, 694272
    buffer_load_dwordx4 v1, s[20:23], s92 offen lds
k2_fill_175:
    s_mov_b32 s85, 0
k2_sw_173:
    s_cmp_ge_u32 s85, s67
    s_cbranch_scc1 k2_se_174
    s_mov_b32 exec_lo, 0xffff0000
    s_mov_b32 exec_hi, 0x0
    v_lshrrev_b32 v96, 16, v2
    v_and_b32 v94, 0xffff, v2
    v_lshl_add_u32 v94, v94, 2, v19
    v_subrev_u32 v95, s85, v6
    v_lshlrev_b32 v95, 2, v95
k2_smap_176:
    v_cmpx_lt_i32 vcc, 0, v96
    s_cbranch_execz k2_smapd_177
    v_min_u32 v93, 4, v96
    v_add3_u32 v93, v93, v94, -1
    s_mov_b64 s[80:81], exec
    v_mov_b32 v97, 4096
    v_cmpx_lt_u32 vcc, v95, v97
    v_add_u32 v98, 134272, v95
    ds_write_b32 v98, v93
    s_mov_b64 exec, s[80:81]
    v_add_u32 v94, 16, v94
    v_add_u32 v95, 4, v95
    v_add_u32 v96, -4, v96
    s_branch k2_smap_176
k2_smapd_177:
    s_mov_b64 exec, -1
    s_waitcnt vmcnt(0) lgkmcnt(0)
    s_barrier
    s_mov_b32 s82, s67
    s_sub_u32 s67, s67, s85
    v_cmp_gt_u32 s[40:41], s67, v0
    v_add_u32 v91, 134272, v102
    ds_read_b32 v34, v91
    s_waitcnt lgkmcnt(0)
    s_mov_b64 s[42:43], 0
    s_mov_b64 s[44:45], 0
    s_mov_b64 s[46:47], 0
    s_mov_b64 exec, s[40:41]
    s_cbranch_execz k2_lr_178
    v_and_b32 v35, -4, v34
    buffer_load_dwordx4 v[28:31], v35, s[24:27], 0 offen
    v_lshrrev_b32 v35, 1, v35
    buffer_load_dwordx2 v[32:33], v35, s[76:79], 0 offen
    v_and_b32 v34, 3, v34
    v_cmp_le_u32 s[42:43], 1, v34
    v_cmp_le_u32 s[44:45], 2, v34
    v_cmp_le_u32 s[46:47], 3, v34
k2_lr_178:
    s_mov_b64 exec, -1
    s_mov_b32 s67, s82
    s_waitcnt vmcnt(0) lgkmcnt(0)
    v_mad_u32_u16 v76, v28, 1, v101
    v_mad_u32_u16 v77, v29, 1, v101
    v_mad_u32_u16 v78, v30, 1, v101
    v_mad_u32_u16 v79, v31, 1, v101
    s_mov_b64 exec, s[40:41]
    ds_read_b64 v[52:53], v76
    s_mov_b64 exec, s[42:43]
    ds_read_b64 v[54:55], v77
    s_mov_b64 exec, s[44:45]
    ds_read_b64 v[56:57], v78
    s_mov_b64 exec, s[46:47]
    ds_read_b64 v[58:59], v79
    s_mov_b64 exec, -1
    s_waitcnt lgkmcnt(0)
    v_lshlrev_b32 v80, 16, v32
    v_lshlrev_b32 v60, 16, v52
    v_and_b32 v61, v103, v52
    v_lshlrev_b32 v62, 16, v53
    v_and_b32 v63, v103, v53
    v_mul_f32 v60, v80, v60
    v_mul_f32 v61, v80, v61
    v_mul_f32 v62, v80, v62
    v_mul_f32 v63, v80, v63
    v_lshrrev_b32 v84, 16, v28
    s_mov_b64 exec, s[40:41]
    ds_add_f32 v84, v60
    ds_add_f32 v84, v61 offset:4
    ds_add_f32 v84, v62 offset:40000
    ds_add_f32 v84, v63 offset:40004
    s_mov_b64 exec, -1
    v_and_b32 v81, v103, v32
    v_lshlrev_b32 v64, 16, v54
    v_and_b32 v65, v103, v54
    v_lshlrev_b32 v66, 16, v55
    v_and_b32 v67, v103, v55
    v_mul_f32 v64, v81, v64
    v_mul_f32 v65, v81, v65
    v_mul_f32 v66, v81, v66
    v_mul_f32 v67, v81, v67
    v_lshrrev_b32 v85, 16, v29
    s_mov_b64 exec, s[42:43]
    ds_add_f32 v85, v64
    ds_add_f32 v85, v65 offset:4
    ds_add_f32 v85, v66 offset:40000
    ds_add_f32 v85, v67 offset:40004
    s_mov_b64 exec, -1
    v_lshlrev_b32 v82, 16, v33
    v_lshlrev_b32 v68, 16, v56
    v_and_b32 v69, v103, v56
    v_lshlrev_b32 v70, 16, v57
    v_and_b32 v71, v103, v57
    v_mul_f32 v68, v82, v68
    v_mul_f32 v69, v82, v69
    v_mul_f32 v70, v82, v70
    v_mul_f32 v71, v82, v71
    v_lshrrev_b32 v86, 16, v30
    s_mov_b64 exec, s[44:45]
    ds_add_f32 v86, v68
    ds_add_f32 v86, v69 offset:4
    ds_add_f32 v86, v70 offset:40000
    ds_add_f32 v86, v71 offset:40004
    s_mov_b64 exec, -1
    v_and_b32 v83, v103, v33
    v_lshlrev_b32 v72, 16, v58
    v_and_b32 v73, v103, v58
    v_lshlrev_b32 v74, 16, v59
    v_and_b32 v75, v103, v59
    v_mul_f32 v72, v83, v72
    v_mul_f32 v73, v83, v73
    v_mul_f32 v74, v83, v74
    v_mul_f32 v75, v83, v75
    v_lshrrev_b32 v87, 16, v31
    s_mov_b64 exec, s[46:47]
    ds_add_f32 v87, v72
    ds_add_f32 v87, v73 offset:4
    ds_add_f32 v87, v74 offset:40000
    ds_add_f32 v87, v75 offset:40004
    s_mov_b64 exec, -1
    s_waitcnt lgkmcnt(0)
    s_barrier
    s_add_u32 s85, s85, 1024
    s_branch k2_sw_173
k2_se_174:
    s_waitcnt vmcnt(0) lgkmcnt(0)
    s_barrier
    s_lshl_b32 s90, s84, 10
    s_mul_i32 s91, s86, 53760
    s_add_u32 m0, s90, 80000
    s_add_u32 s92, s91, 860160
    buffer_load_dwordx4 v1, s[20:23], s92 offen lds
    s_add_u32 m0, s90, 96384
    s_add_u32 s92, s91, 876544
    buffer_load_dwordx4 v1, s[20:23], s92 offen lds
    s_add_u32 m0, s90, 112768
    s_add_u32 s92, s91, 892928
    buffer_load_dwordx4 v1, s[20:23], s92 offen lds
    s_cmp_ge_u32 s84, 5
    s_cbranch_scc1 k2_fill_181
    s_add_u32 m0, s90, 129152
    s_add_u32 s92, s91, 909312
    buffer_load_dwordx4 v1, s[20:23], s92 offen lds
k2_fill_181:
    s_mov_b32 s85, 0
k2_sw_179:
    s_cmp_ge_u32 s85, s68
    s_cbranch_scc1 k2_se_180
    s_mov_b32 exec_lo, 0xffff0000
    s_mov_b32 exec_hi, 0x0
    v_lshrrev_b32 v96, 16, v3
    v_and_b32 v94, 0xffff, v3
    v_lshl_add_u32 v94, v94, 2, v19
    v_subrev_u32 v95, s85, v7
    v_lshlrev_b32 v95, 2, v95
k2_smap_182:
    v_cmpx_lt_i32 vcc, 0, v96
    s_cbranch_execz k2_smapd_183
    v_min_u32 v93, 4, v96
    v_add3_u32 v93, v93, v94, -1
    s_mov_b64 s[80:81], exec
    v_mov_b32 v97, 4096
    v_cmpx_lt_u32 vcc, v95, v97
    v_add_u32 v98, 134272, v95
    ds_write_b32 v98, v93
    s_mov_b64 exec, s[80:81]
    v_add_u32 v94, 16, v94
    v_add_u32 v95, 4, v95
    v_add_u32 v96, -4, v96
    s_branch k2_smap_182
k2_smapd_183:
    s_mov_b64 exec, -1
    s_waitcnt vmcnt(0) lgkmcnt(0)
    s_barrier
    s_mov_b32 s82, s68
    s_sub_u32 s68, s68, s85
    v_cmp_gt_u32 s[40:41], s68, v0
    v_add_u32 v91, 134272, v102
    ds_read_b32 v34, v91
    s_waitcnt lgkmcnt(0)
    s_mov_b64 s[42:43], 0
    s_mov_b64 s[44:45], 0
    s_mov_b64 s[46:47], 0
    s_mov_b64 exec, s[40:41]
    s_cbranch_execz k2_lr_184
    v_and_b32 v35, -4, v34
    buffer_load_dwordx4 v[28:31], v35, s[24:27], 0 offen
    v_lshrrev_b32 v35, 1, v35
    buffer_load_dwordx2 v[32:33], v35, s[76:79], 0 offen
    v_and_b32 v34, 3, v34
    v_cmp_le_u32 s[42:43], 1, v34
    v_cmp_le_u32 s[44:45], 2, v34
    v_cmp_le_u32 s[46:47], 3, v34
k2_lr_184:
    s_mov_b64 exec, -1
    s_mov_b32 s68, s82
    s_waitcnt vmcnt(0) lgkmcnt(0)
    v_mad_u32_u16 v76, v28, 1, v101
    v_mad_u32_u16 v77, v29, 1, v101
    v_mad_u32_u16 v78, v30, 1, v101
    v_mad_u32_u16 v79, v31, 1, v101
    s_mov_b64 exec, s[40:41]
    ds_read_b64 v[52:53], v76
    s_mov_b64 exec, s[42:43]
    ds_read_b64 v[54:55], v77
    s_mov_b64 exec, s[44:45]
    ds_read_b64 v[56:57], v78
    s_mov_b64 exec, s[46:47]
    ds_read_b64 v[58:59], v79
    s_mov_b64 exec, -1
    s_waitcnt lgkmcnt(0)
    v_lshlrev_b32 v80, 16, v32
    v_lshlrev_b32 v60, 16, v52
    v_and_b32 v61, v103, v52
    v_lshlrev_b32 v62, 16, v53
    v_and_b32 v63, v103, v53
    v_mul_f32 v60, v80, v60
    v_mul_f32 v61, v80, v61
    v_mul_f32 v62, v80, v62
    v_mul_f32 v63, v80, v63
    v_lshrrev_b32 v84, 16, v28
    s_mov_b64 exec, s[40:41]
    ds_add_f32 v84, v60
    ds_add_f32 v84, v61 offset:4
    ds_add_f32 v84, v62 offset:40000
    ds_add_f32 v84, v63 offset:40004
    s_mov_b64 exec, -1
    v_and_b32 v81, v103, v32
    v_lshlrev_b32 v64, 16, v54
    v_and_b32 v65, v103, v54
    v_lshlrev_b32 v66, 16, v55
    v_and_b32 v67, v103, v55
    v_mul_f32 v64, v81, v64
    v_mul_f32 v65, v81, v65
    v_mul_f32 v66, v81, v66
    v_mul_f32 v67, v81, v67
    v_lshrrev_b32 v85, 16, v29
    s_mov_b64 exec, s[42:43]
    ds_add_f32 v85, v64
    ds_add_f32 v85, v65 offset:4
    ds_add_f32 v85, v66 offset:40000
    ds_add_f32 v85, v67 offset:40004
    s_mov_b64 exec, -1
    v_lshlrev_b32 v82, 16, v33
    v_lshlrev_b32 v68, 16, v56
    v_and_b32 v69, v103, v56
    v_lshlrev_b32 v70, 16, v57
    v_and_b32 v71, v103, v57
    v_mul_f32 v68, v82, v68
    v_mul_f32 v69, v82, v69
    v_mul_f32 v70, v82, v70
    v_mul_f32 v71, v82, v71
    v_lshrrev_b32 v86, 16, v30
    s_mov_b64 exec, s[44:45]
    ds_add_f32 v86, v68
    ds_add_f32 v86, v69 offset:4
    ds_add_f32 v86, v70 offset:40000
    ds_add_f32 v86, v71 offset:40004
    s_mov_b64 exec, -1
    v_and_b32 v83, v103, v33
    v_lshlrev_b32 v72, 16, v58
    v_and_b32 v73, v103, v58
    v_lshlrev_b32 v74, 16, v59
    v_and_b32 v75, v103, v59
    v_mul_f32 v72, v83, v72
    v_mul_f32 v73, v83, v73
    v_mul_f32 v74, v83, v74
    v_mul_f32 v75, v83, v75
    v_lshrrev_b32 v87, 16, v31
    s_mov_b64 exec, s[46:47]
    ds_add_f32 v87, v72
    ds_add_f32 v87, v73 offset:4
    ds_add_f32 v87, v74 offset:40000
    ds_add_f32 v87, v75 offset:40004
    s_mov_b64 exec, -1
    s_waitcnt lgkmcnt(0)
    s_barrier
    s_add_u32 s85, s85, 1024
    s_branch k2_sw_179
k2_se_180:
    s_waitcnt vmcnt(0) lgkmcnt(0)
    s_barrier
    s_lshl_b32 s90, s84, 10
    s_mul_i32 s91, s86, 53760
    s_add_u32 m0, s90, 80000
    s_add_u32 s92, s91, 1075200
    buffer_load_dwordx4 v1, s[20:23], s92 offen lds
    s_add_u32 m0, s90, 96384
    s_add_u32 s92, s91, 1091584
    buffer_load_dwordx4 v1, s[20:23], s92 offen lds
    s_add_u32 m0, s90, 112768
    s_add_u32 s92, s91, 1107968
    buffer_load_dwordx4 v1, s[20:23], s92 offen lds
    s_cmp_ge_u32 s84, 5
    s_cbranch_scc1 k2_fill_187
    s_add_u32 m0, s90, 129152
    s_add_u32 s92, s91, 1124352
    buffer_load_dwordx4 v1, s[20:23], s92 offen lds
k2_fill_187:
    s_mov_b32 s85, 0
k2_sw_185:
    s_cmp_ge_u32 s85, s69
    s_cbranch_scc1 k2_se_186
    s_mov_b32 exec_lo, 0xffff0000
    s_mov_b32 exec_hi, 0x0
    v_lshrrev_b32 v96, 16, v4
    v_and_b32 v94, 0xffff, v4
    v_lshl_add_u32 v94, v94, 2, v19
    v_subrev_u32 v95, s85, v8
    v_lshlrev_b32 v95, 2, v95
k2_smap_188:
    v_cmpx_lt_i32 vcc, 0, v96
    s_cbranch_execz k2_smapd_189
    v_min_u32 v93, 4, v96
    v_add3_u32 v93, v93, v94, -1
    s_mov_b64 s[80:81], exec
    v_mov_b32 v97, 4096
    v_cmpx_lt_u32 vcc, v95, v97
    v_add_u32 v98, 134272, v95
    ds_write_b32 v98, v93
    s_mov_b64 exec, s[80:81]
    v_add_u32 v94, 16, v94
    v_add_u32 v95, 4, v95
    v_add_u32 v96, -4, v96
    s_branch k2_smap_188
k2_smapd_189:
    s_mov_b64 exec, -1
    s_waitcnt vmcnt(0) lgkmcnt(0)
    s_barrier
    s_mov_b32 s82, s69
    s_sub_u32 s69, s69, s85
    v_cmp_gt_u32 s[40:41], s69, v0
    v_add_u32 v91, 134272, v102
    ds_read_b32 v34, v91
    s_waitcnt lgkmcnt(0)
    s_mov_b64 s[42:43], 0
    s_mov_b64 s[44:45], 0
    s_mov_b64 s[46:47], 0
    s_mov_b64 exec, s[40:41]
    s_cbranch_execz k2_lr_190
    v_and_b32 v35, -4, v34
    buffer_load_dwordx4 v[28:31], v35, s[24:27], 0 offen
    v_lshrrev_b32 v35, 1, v35
    buffer_load_dwordx2 v[32:33], v35, s[76:79], 0 offen
    v_and_b32 v34, 3, v34
    v_cmp_le_u32 s[42:43], 1, v34
    v_cmp_le_u32 s[44:45], 2, v34
    v_cmp_le_u32 s[46:47], 3, v34
k2_lr_190:
    s_mov_b64 exec, -1
    s_mov_b32 s69, s82
    s_waitcnt vmcnt(0) lgkmcnt(0)
    v_mad_u32_u16 v76, v28, 1, v101
    v_mad_u32_u16 v77, v29, 1, v101
    v_mad_u32_u16 v78, v30, 1, v101
    v_mad_u32_u16 v79, v31, 1, v101
    s_mov_b64 exec, s[40:41]
    ds_read_b64 v[52:53], v76
    s_mov_b64 exec, s[42:43]
    ds_read_b64 v[54:55], v77
    s_mov_b64 exec, s[44:45]
    ds_read_b64 v[56:57], v78
    s_mov_b64 exec, s[46:47]
    ds_read_b64 v[58:59], v79
    s_mov_b64 exec, -1
    s_waitcnt lgkmcnt(0)
    v_lshlrev_b32 v80, 16, v32
    v_lshlrev_b32 v60, 16, v52
    v_and_b32 v61, v103, v52
    v_lshlrev_b32 v62, 16, v53
    v_and_b32 v63, v103, v53
    v_mul_f32 v60, v80, v60
    v_mul_f32 v61, v80, v61
    v_mul_f32 v62, v80, v62
    v_mul_f32 v63, v80, v63
    v_lshrrev_b32 v84, 16, v28
    s_mov_b64 exec, s[40:41]
    ds_add_f32 v84, v60
    ds_add_f32 v84, v61 offset:4
    ds_add_f32 v84, v62 offset:40000
    ds_add_f32 v84, v63 offset:40004
    s_mov_b64 exec, -1
    v_and_b32 v81, v103, v32
    v_lshlrev_b32 v64, 16, v54
    v_and_b32 v65, v103, v54
    v_lshlrev_b32 v66, 16, v55
    v_and_b32 v67, v103, v55
    v_mul_f32 v64, v81, v64
    v_mul_f32 v65, v81, v65
    v_mul_f32 v66, v81, v66
    v_mul_f32 v67, v81, v67
    v_lshrrev_b32 v85, 16, v29
    s_mov_b64 exec, s[42:43]
    ds_add_f32 v85, v64
    ds_add_f32 v85, v65 offset:4
    ds_add_f32 v85, v66 offset:40000
    ds_add_f32 v85, v67 offset:40004
    s_mov_b64 exec, -1
    v_lshlrev_b32 v82, 16, v33
    v_lshlrev_b32 v68, 16, v56
    v_and_b32 v69, v103, v56
    v_lshlrev_b32 v70, 16, v57
    v_and_b32 v71, v103, v57
    v_mul_f32 v68, v82, v68
    v_mul_f32 v69, v82, v69
    v_mul_f32 v70, v82, v70
    v_mul_f32 v71, v82, v71
    v_lshrrev_b32 v86, 16, v30
    s_mov_b64 exec, s[44:45]
    ds_add_f32 v86, v68
    ds_add_f32 v86, v69 offset:4
    ds_add_f32 v86, v70 offset:40000
    ds_add_f32 v86, v71 offset:40004
    s_mov_b64 exec, -1
    v_and_b32 v83, v103, v33
    v_lshlrev_b32 v72, 16, v58
    v_and_b32 v73, v103, v58
    v_lshlrev_b32 v74, 16, v59
    v_and_b32 v75, v103, v59
    v_mul_f32 v72, v83, v72
    v_mul_f32 v73, v83, v73
    v_mul_f32 v74, v83, v74
    v_mul_f32 v75, v83, v75
    v_lshrrev_b32 v87, 16, v31
    s_mov_b64 exec, s[46:47]
    ds_add_f32 v87, v72
    ds_add_f32 v87, v73 offset:4
    ds_add_f32 v87, v74 offset:40000
    ds_add_f32 v87, v75 offset:40004
    s_mov_b64 exec, -1
    s_waitcnt lgkmcnt(0)
    s_barrier
    s_add_u32 s85, s85, 1024
    s_branch k2_sw_185
k2_se_186:
    s_waitcnt vmcnt(0) lgkmcnt(0)
    s_barrier
    s_lshl_b32 s90, s84, 10
    s_mul_i32 s91, s86, 53760
    s_add_u32 m0, s90, 80000
    s_add_u32 s92, s91, 1290240
    buffer_load_dwordx4 v1, s[20:23], s92 offen lds
    s_add_u32 m0, s90, 96384
    s_add_u32 s92, s91, 1306624
    buffer_load_dwordx4 v1, s[20:23], s92 offen lds
    s_add_u32 m0, s90, 112768
    s_add_u32 s92, s91, 1323008
    buffer_load_dwordx4 v1, s[20:23], s92 offen lds
    s_cmp_ge_u32 s84, 5
    s_cbranch_scc1 k2_fill_193
    s_add_u32 m0, s90, 129152
    s_add_u32 s92, s91, 1339392
    buffer_load_dwordx4 v1, s[20:23], s92 offen lds
k2_fill_193:
    s_mov_b32 s85, 0
k2_sw_191:
    s_cmp_ge_u32 s85, s70
    s_cbranch_scc1 k2_se_192
    s_mov_b32 exec_lo, 0x0
    s_mov_b32 exec_hi, 0xffff
    v_lshrrev_b32 v96, 16, v2
    v_and_b32 v94, 0xffff, v2
    v_lshl_add_u32 v94, v94, 2, v19
    v_subrev_u32 v95, s85, v6
    v_lshlrev_b32 v95, 2, v95
k2_smap_194:
    v_cmpx_lt_i32 vcc, 0, v96
    s_cbranch_execz k2_smapd_195
    v_min_u32 v93, 4, v96
    v_add3_u32 v93, v93, v94, -1
    s_mov_b64 s[80:81], exec
    v_mov_b32 v97, 4096
    v_cmpx_lt_u32 vcc, v95, v97
    v_add_u32 v98, 134272, v95
    ds_write_b32 v98, v93
    s_mov_b64 exec, s[80:81]
    v_add_u32 v94, 16, v94
    v_add_u32 v95, 4, v95
    v_add_u32 v96, -4, v96
    s_branch k2_smap_194
k2_smapd_195:
    s_mov_b64 exec, -1
    s_waitcnt vmcnt(0) lgkmcnt(0)
    s_barrier
    s_mov_b32 s82, s70
    s_sub_u32 s70, s70, s85
    v_cmp_gt_u32 s[40:41], s70, v0
    v_add_u32 v91, 134272, v102
    ds_read_b32 v34, v91
    s_waitcnt lgkmcnt(0)
    s_mov_b64 s[42:43], 0
    s_mov_b64 s[44:45], 0
    s_mov_b64 s[46:47], 0
    s_mov_b64 exec, s[40:41]
    s_cbranch_execz k2_lr_196
    v_and_b32 v35, -4, v34
    buffer_load_dwordx4 v[28:31], v35, s[24:27], 0 offen
    v_lshrrev_b32 v35, 1, v35
    buffer_load_dwordx2 v[32:33], v35, s[76:79], 0 offen
    v_and_b32 v34, 3, v34
    v_cmp_le_u32 s[42:43], 1, v34
    v_cmp_le_u32 s[44:45], 2, v34
    v_cmp_le_u32 s[46:47], 3, v34
k2_lr_196:
    s_mov_b64 exec, -1
    s_mov_b32 s70, s82
    s_waitcnt vmcnt(0) lgkmcnt(0)
    v_mad_u32_u16 v76, v28, 1, v101
    v_mad_u32_u16 v77, v29, 1, v101
    v_mad_u32_u16 v78, v30, 1, v101
    v_mad_u32_u16 v79, v31, 1, v101
    s_mov_b64 exec, s[40:41]
    ds_read_b64 v[52:53], v76
    s_mov_b64 exec, s[42:43]
    ds_read_b64 v[54:55], v77
    s_mov_b64 exec, s[44:45]
    ds_read_b64 v[56:57], v78
    s_mov_b64 exec, s[46:47]
    ds_read_b64 v[58:59], v79
    s_mov_b64 exec, -1
    s_waitcnt lgkmcnt(0)
    v_lshlrev_b32 v80, 16, v32
    v_lshlrev_b32 v60, 16, v52
    v_and_b32 v61, v103, v52
    v_lshlrev_b32 v62, 16, v53
    v_and_b32 v63, v103, v53
    v_mul_f32 v60, v80, v60
    v_mul_f32 v61, v80, v61
    v_mul_f32 v62, v80, v62
    v_mul_f32 v63, v80, v63
    v_lshrrev_b32 v84, 16, v28
    s_mov_b64 exec, s[40:41]
    ds_add_f32 v84, v60
    ds_add_f32 v84, v61 offset:4
    ds_add_f32 v84, v62 offset:40000
    ds_add_f32 v84, v63 offset:40004
    s_mov_b64 exec, -1
    v_and_b32 v81, v103, v32
    v_lshlrev_b32 v64, 16, v54
    v_and_b32 v65, v103, v54
    v_lshlrev_b32 v66, 16, v55
    v_and_b32 v67, v103, v55
    v_mul_f32 v64, v81, v64
    v_mul_f32 v65, v81, v65
    v_mul_f32 v66, v81, v66
    v_mul_f32 v67, v81, v67
    v_lshrrev_b32 v85, 16, v29
    s_mov_b64 exec, s[42:43]
    ds_add_f32 v85, v64
    ds_add_f32 v85, v65 offset:4
    ds_add_f32 v85, v66 offset:40000
    ds_add_f32 v85, v67 offset:40004
    s_mov_b64 exec, -1
    v_lshlrev_b32 v82, 16, v33
    v_lshlrev_b32 v68, 16, v56
    v_and_b32 v69, v103, v56
    v_lshlrev_b32 v70, 16, v57
    v_and_b32 v71, v103, v57
    v_mul_f32 v68, v82, v68
    v_mul_f32 v69, v82, v69
    v_mul_f32 v70, v82, v70
    v_mul_f32 v71, v82, v71
    v_lshrrev_b32 v86, 16, v30
    s_mov_b64 exec, s[44:45]
    ds_add_f32 v86, v68
    ds_add_f32 v86, v69 offset:4
    ds_add_f32 v86, v70 offset:40000
    ds_add_f32 v86, v71 offset:40004
    s_mov_b64 exec, -1
    v_and_b32 v83, v103, v33
    v_lshlrev_b32 v72, 16, v58
    v_and_b32 v73, v103, v58
    v_lshlrev_b32 v74, 16, v59
    v_and_b32 v75, v103, v59
    v_mul_f32 v72, v83, v72
    v_mul_f32 v73, v83, v73
    v_mul_f32 v74, v83, v74
    v_mul_f32 v75, v83, v75
    v_lshrrev_b32 v87, 16, v31
    s_mov_b64 exec, s[46:47]
    ds_add_f32 v87, v72
    ds_add_f32 v87, v73 offset:4
    ds_add_f32 v87, v74 offset:40000
    ds_add_f32 v87, v75 offset:40004
    s_mov_b64 exec, -1
    s_waitcnt lgkmcnt(0)
    s_barrier
    s_add_u32 s85, s85, 1024
    s_branch k2_sw_191
k2_se_192:
    s_waitcnt vmcnt(0) lgkmcnt(0)
    s_barrier
    s_lshl_b32 s90, s84, 10
    s_mul_i32 s91, s86, 53760
    s_add_u32 m0, s90, 80000
    s_add_u32 s92, s91, 1505280
    buffer_load_dwordx4 v1, s[20:23], s92 offen lds
    s_add_u32 m0, s90, 96384
    s_add_u32 s92, s91, 1521664
    buffer_load_dwordx4 v1, s[20:23], s92 offen lds
    s_add_u32 m0, s90, 112768
    s_add_u32 s92, s91, 1538048
    buffer_load_dwordx4 v1, s[20:23], s92 offen lds
    s_cmp_ge_u32 s84, 5
    s_cbranch_scc1 k2_fill_199
    s_add_u32 m0, s90, 129152
    s_add_u32 s92, s91, 1554432
    buffer_load_dwordx4 v1, s[20:23], s92 offen lds
k2_fill_199:
    s_mov_b32 s85, 0
k2_sw_197:
    s_cmp_ge_u32 s85, s71
    s_cbranch_scc1 k2_se_198
    s_mov_b32 exec_lo, 0x0
    s_mov_b32 exec_hi, 0xffff
    v_lshrrev_b32 v96, 16, v3
    v_and_b32 v94, 0xffff, v3
    v_lshl_add_u32 v94, v94, 2, v19
    v_subrev_u32 v95, s85, v7
    v_lshlrev_b32 v95, 2, v95
k2_smap_200:
    v_cmpx_lt_i32 vcc, 0, v96
    s_cbranch_execz k2_smapd_201
    v_min_u32 v93, 4, v96
    v_add3_u32 v93, v93, v94, -1
    s_mov_b64 s[80:81], exec
    v_mov_b32 v97, 4096
    v_cmpx_lt_u32 vcc, v95, v97
    v_add_u32 v98, 134272, v95
    ds_write_b32 v98, v93
    s_mov_b64 exec, s[80:81]
    v_add_u32 v94, 16, v94
    v_add_u32 v95, 4, v95
    v_add_u32 v96, -4, v96
    s_branch k2_smap_200
k2_smapd_201:
    s_mov_b64 exec, -1
    s_waitcnt vmcnt(0) lgkmcnt(0)
    s_barrier
    s_mov_b32 s82, s71
    s_sub_u32 s71, s71, s85
    v_cmp_gt_u32 s[40:41], s71, v0
    v_add_u32 v91, 134272, v102
    ds_read_b32 v34, v91
    s_waitcnt lgkmcnt(0)
    s_mov_b64 s[42:43], 0
    s_mov_b64 s[44:45], 0
    s_mov_b64 s[46:47], 0
    s_mov_b64 exec, s[40:41]
    s_cbranch_execz k2_lr_202
    v_and_b32 v35, -4, v34
    buffer_load_dwordx4 v[28:31], v35, s[24:27], 0 offen
    v_lshrrev_b32 v35, 1, v35
    buffer_load_dwordx2 v[32:33], v35, s[76:79], 0 offen
    v_and_b32 v34, 3, v34
    v_cmp_le_u32 s[42:43], 1, v34
    v_cmp_le_u32 s[44:45], 2, v34
    v_cmp_le_u32 s[46:47], 3, v34
k2_lr_202:
    s_mov_b64 exec, -1
    s_mov_b32 s71, s82
    s_waitcnt vmcnt(0) lgkmcnt(0)
    v_mad_u32_u16 v76, v28, 1, v101
    v_mad_u32_u16 v77, v29, 1, v101
    v_mad_u32_u16 v78, v30, 1, v101
    v_mad_u32_u16 v79, v31, 1, v101
    s_mov_b64 exec, s[40:41]
    ds_read_b64 v[52:53], v76
    s_mov_b64 exec, s[42:43]
    ds_read_b64 v[54:55], v77
    s_mov_b64 exec, s[44:45]
    ds_read_b64 v[56:57], v78
    s_mov_b64 exec, s[46:47]
    ds_read_b64 v[58:59], v79
    s_mov_b64 exec, -1
    s_waitcnt lgkmcnt(0)
    v_lshlrev_b32 v80, 16, v32
    v_lshlrev_b32 v60, 16, v52
    v_and_b32 v61, v103, v52
    v_lshlrev_b32 v62, 16, v53
    v_and_b32 v63, v103, v53
    v_mul_f32 v60, v80, v60
    v_mul_f32 v61, v80, v61
    v_mul_f32 v62, v80, v62
    v_mul_f32 v63, v80, v63
    v_lshrrev_b32 v84, 16, v28
    s_mov_b64 exec, s[40:41]
    ds_add_f32 v84, v60
    ds_add_f32 v84, v61 offset:4
    ds_add_f32 v84, v62 offset:40000
    ds_add_f32 v84, v63 offset:40004
    s_mov_b64 exec, -1
    v_and_b32 v81, v103, v32
    v_lshlrev_b32 v64, 16, v54
    v_and_b32 v65, v103, v54
    v_lshlrev_b32 v66, 16, v55
    v_and_b32 v67, v103, v55
    v_mul_f32 v64, v81, v64
    v_mul_f32 v65, v81, v65
    v_mul_f32 v66, v81, v66
    v_mul_f32 v67, v81, v67
    v_lshrrev_b32 v85, 16, v29
    s_mov_b64 exec, s[42:43]
    ds_add_f32 v85, v64
    ds_add_f32 v85, v65 offset:4
    ds_add_f32 v85, v66 offset:40000
    ds_add_f32 v85, v67 offset:40004
    s_mov_b64 exec, -1
    v_lshlrev_b32 v82, 16, v33
    v_lshlrev_b32 v68, 16, v56
    v_and_b32 v69, v103, v56
    v_lshlrev_b32 v70, 16, v57
    v_and_b32 v71, v103, v57
    v_mul_f32 v68, v82, v68
    v_mul_f32 v69, v82, v69
    v_mul_f32 v70, v82, v70
    v_mul_f32 v71, v82, v71
    v_lshrrev_b32 v86, 16, v30
    s_mov_b64 exec, s[44:45]
    ds_add_f32 v86, v68
    ds_add_f32 v86, v69 offset:4
    ds_add_f32 v86, v70 offset:40000
    ds_add_f32 v86, v71 offset:40004
    s_mov_b64 exec, -1
    v_and_b32 v83, v103, v33
    v_lshlrev_b32 v72, 16, v58
    v_and_b32 v73, v103, v58
    v_lshlrev_b32 v74, 16, v59
    v_and_b32 v75, v103, v59
    v_mul_f32 v72, v83, v72
    v_mul_f32 v73, v83, v73
    v_mul_f32 v74, v83, v74
    v_mul_f32 v75, v83, v75
    v_lshrrev_b32 v87, 16, v31
    s_mov_b64 exec, s[46:47]
    ds_add_f32 v87, v72
    ds_add_f32 v87, v73 offset:4
    ds_add_f32 v87, v74 offset:40000
    ds_add_f32 v87, v75 offset:40004
    s_mov_b64 exec, -1
    s_waitcnt lgkmcnt(0)
    s_barrier
    s_add_u32 s85, s85, 1024
    s_branch k2_sw_197
k2_se_198:
    s_waitcnt vmcnt(0) lgkmcnt(0)
    s_barrier
    s_lshl_b32 s90, s84, 10
    s_mul_i32 s91, s86, 53760
    s_add_u32 m0, s90, 80000
    s_add_u32 s92, s91, 1720320
    buffer_load_dwordx4 v1, s[20:23], s92 offen lds
    s_add_u32 m0, s90, 96384
    s_add_u32 s92, s91, 1736704
    buffer_load_dwordx4 v1, s[20:23], s92 offen lds
    s_add_u32 m0, s90, 112768
    s_add_u32 s92, s91, 1753088
    buffer_load_dwordx4 v1, s[20:23], s92 offen lds
    s_cmp_ge_u32 s84, 5
    s_cbranch_scc1 k2_fill_205
    s_add_u32 m0, s90, 129152
    s_add_u32 s92, s91, 1769472
    buffer_load_dwordx4 v1, s[20:23], s92 offen lds
k2_fill_205:
    s_mov_b32 s85, 0
k2_sw_203:
    s_cmp_ge_u32 s85, s72
    s_cbranch_scc1 k2_se_204
    s_mov_b32 exec_lo, 0x0
    s_mov_b32 exec_hi, 0xffff
    v_lshrrev_b32 v96, 16, v4
    v_and_b32 v94, 0xffff, v4
    v_lshl_add_u32 v94, v94, 2, v19
    v_subrev_u32 v95, s85, v8
    v_lshlrev_b32 v95, 2, v95
k2_smap_206:
    v_cmpx_lt_i32 vcc, 0, v96
    s_cbranch_execz k2_smapd_207
    v_min_u32 v93, 4, v96
    v_add3_u32 v93, v93, v94, -1
    s_mov_b64 s[80:81], exec
    v_mov_b32 v97, 4096
    v_cmpx_lt_u32 vcc, v95, v97
    v_add_u32 v98, 134272, v95
    ds_write_b32 v98, v93
    s_mov_b64 exec, s[80:81]
    v_add_u32 v94, 16, v94
    v_add_u32 v95, 4, v95
    v_add_u32 v96, -4, v96
    s_branch k2_smap_206
k2_smapd_207:
    s_mov_b64 exec, -1
    s_waitcnt vmcnt(0) lgkmcnt(0)
    s_barrier
    s_mov_b32 s82, s72
    s_sub_u32 s72, s72, s85
    v_cmp_gt_u32 s[40:41], s72, v0
    v_add_u32 v91, 134272, v102
    ds_read_b32 v34, v91
    s_waitcnt lgkmcnt(0)
    s_mov_b64 s[42:43], 0
    s_mov_b64 s[44:45], 0
    s_mov_b64 s[46:47], 0
    s_mov_b64 exec, s[40:41]
    s_cbranch_execz k2_lr_208
    v_and_b32 v35, -4, v34
    buffer_load_dwordx4 v[28:31], v35, s[24:27], 0 offen
    v_lshrrev_b32 v35, 1, v35
    buffer_load_dwordx2 v[32:33], v35, s[76:79], 0 offen
    v_and_b32 v34, 3, v34
    v_cmp_le_u32 s[42:43], 1, v34
    v_cmp_le_u32 s[44:45], 2, v34
    v_cmp_le_u32 s[46:47], 3, v34
k2_lr_208:
    s_mov_b64 exec, -1
    s_mov_b32 s72, s82
    s_waitcnt vmcnt(0) lgkmcnt(0)
    v_mad_u32_u16 v76, v28, 1, v101
    v_mad_u32_u16 v77, v29, 1, v101
    v_mad_u32_u16 v78, v30, 1, v101
    v_mad_u32_u16 v79, v31, 1, v101
    s_mov_b64 exec, s[40:41]
    ds_read_b64 v[52:53], v76
    s_mov_b64 exec, s[42:43]
    ds_read_b64 v[54:55], v77
    s_mov_b64 exec, s[44:45]
    ds_read_b64 v[56:57], v78
    s_mov_b64 exec, s[46:47]
    ds_read_b64 v[58:59], v79
    s_mov_b64 exec, -1
    s_waitcnt lgkmcnt(0)
    v_lshlrev_b32 v80, 16, v32
    v_lshlrev_b32 v60, 16, v52
    v_and_b32 v61, v103, v52
    v_lshlrev_b32 v62, 16, v53
    v_and_b32 v63, v103, v53
    v_mul_f32 v60, v80, v60
    v_mul_f32 v61, v80, v61
    v_mul_f32 v62, v80, v62
    v_mul_f32 v63, v80, v63
    v_lshrrev_b32 v84, 16, v28
    s_mov_b64 exec, s[40:41]
    ds_add_f32 v84, v60
    ds_add_f32 v84, v61 offset:4
    ds_add_f32 v84, v62 offset:40000
    ds_add_f32 v84, v63 offset:40004
    s_mov_b64 exec, -1
    v_and_b32 v81, v103, v32
    v_lshlrev_b32 v64, 16, v54
    v_and_b32 v65, v103, v54
    v_lshlrev_b32 v66, 16, v55
    v_and_b32 v67, v103, v55
    v_mul_f32 v64, v81, v64
    v_mul_f32 v65, v81, v65
    v_mul_f32 v66, v81, v66
    v_mul_f32 v67, v81, v67
    v_lshrrev_b32 v85, 16, v29
    s_mov_b64 exec, s[42:43]
    ds_add_f32 v85, v64
    ds_add_f32 v85, v65 offset:4
    ds_add_f32 v85, v66 offset:40000
    ds_add_f32 v85, v67 offset:40004
    s_mov_b64 exec, -1
    v_lshlrev_b32 v82, 16, v33
    v_lshlrev_b32 v68, 16, v56
    v_and_b32 v69, v103, v56
    v_lshlrev_b32 v70, 16, v57
    v_and_b32 v71, v103, v57
    v_mul_f32 v68, v82, v68
    v_mul_f32 v69, v82, v69
    v_mul_f32 v70, v82, v70
    v_mul_f32 v71, v82, v71
    v_lshrrev_b32 v86, 16, v30
    s_mov_b64 exec, s[44:45]
    ds_add_f32 v86, v68
    ds_add_f32 v86, v69 offset:4
    ds_add_f32 v86, v70 offset:40000
    ds_add_f32 v86, v71 offset:40004
    s_mov_b64 exec, -1
    v_and_b32 v83, v103, v33
    v_lshlrev_b32 v72, 16, v58
    v_and_b32 v73, v103, v58
    v_lshlrev_b32 v74, 16, v59
    v_and_b32 v75, v103, v59
    v_mul_f32 v72, v83, v72
    v_mul_f32 v73, v83, v73
    v_mul_f32 v74, v83, v74
    v_mul_f32 v75, v83, v75
    v_lshrrev_b32 v87, 16, v31
    s_mov_b64 exec, s[46:47]
    ds_add_f32 v87, v72
    ds_add_f32 v87, v73 offset:4
    ds_add_f32 v87, v74 offset:40000
    ds_add_f32 v87, v75 offset:40004
    s_mov_b64 exec, -1
    s_waitcnt lgkmcnt(0)
    s_barrier
    s_add_u32 s85, s85, 1024
    s_branch k2_sw_203
k2_se_204:
    s_waitcnt vmcnt(0) lgkmcnt(0)
    s_barrier
    s_lshl_b32 s90, s84, 10
    s_mul_i32 s91, s86, 53760
    s_add_u32 m0, s90, 80000
    s_add_u32 s92, s91, 1935360
    buffer_load_dwordx4 v1, s[20:23], s92 offen lds
    s_add_u32 m0, s90, 96384
    s_add_u32 s92, s91, 1951744
    buffer_load_dwordx4 v1, s[20:23], s92 offen lds
    s_add_u32 m0, s90, 112768
    s_add_u32 s92, s91, 1968128
    buffer_load_dwordx4 v1, s[20:23], s92 offen lds
    s_cmp_ge_u32 s84, 5
    s_cbranch_scc1 k2_fill_211
    s_add_u32 m0, s90, 129152
    s_add_u32 s92, s91, 1984512
    buffer_load_dwordx4 v1, s[20:23], s92 offen lds
k2_fill_211:
    s_mov_b32 s85, 0
k2_sw_209:
    s_cmp_ge_u32 s85, s73
    s_cbranch_scc1 k2_se_210
    s_mov_b32 exec_lo, 0x0
    s_mov_b32 exec_hi, 0xffff0000
    v_lshrrev_b32 v96, 16, v2
    v_and_b32 v94, 0xffff, v2
    v_lshl_add_u32 v94, v94, 2, v19
    v_subrev_u32 v95, s85, v6
    v_lshlrev_b32 v95, 2, v95
k2_smap_212:
    v_cmpx_lt_i32 vcc, 0, v96
    s_cbranch_execz k2_smapd_213
    v_min_u32 v93, 4, v96
    v_add3_u32 v93, v93, v94, -1
    s_mov_b64 s[80:81], exec
    v_mov_b32 v97, 4096
    v_cmpx_lt_u32 vcc, v95, v97
    v_add_u32 v98, 134272, v95
    ds_write_b32 v98, v93
    s_mov_b64 exec, s[80:81]
    v_add_u32 v94, 16, v94
    v_add_u32 v95, 4, v95
    v_add_u32 v96, -4, v96
    s_branch k2_smap_212
k2_smapd_213:
    s_mov_b64 exec, -1
    s_waitcnt vmcnt(0) lgkmcnt(0)
    s_barrier
    s_mov_b32 s82, s73
    s_sub_u32 s73, s73, s85
    v_cmp_gt_u32 s[40:41], s73, v0
    v_add_u32 v91, 134272, v102
    ds_read_b32 v34, v91
    s_waitcnt lgkmcnt(0)
    s_mov_b64 s[42:43], 0
    s_mov_b64 s[44:45], 0
    s_mov_b64 s[46:47], 0
    s_mov_b64 exec, s[40:41]
    s_cbranch_execz k2_lr_214
    v_and_b32 v35, -4, v34
    buffer_load_dwordx4 v[28:31], v35, s[24:27], 0 offen
    v_lshrrev_b32 v35, 1, v35
    buffer_load_dwordx2 v[32:33], v35, s[76:79], 0 offen
    v_and_b32 v34, 3, v34
    v_cmp_le_u32 s[42:43], 1, v34
    v_cmp_le_u32 s[44:45], 2, v34
    v_cmp_le_u32 s[46:47], 3, v34
k2_lr_214:
    s_mov_b64 exec, -1
    s_mov_b32 s73, s82
    s_waitcnt vmcnt(0) lgkmcnt(0)
    v_mad_u32_u16 v76, v28, 1, v101
    v_mad_u32_u16 v77, v29, 1, v101
    v_mad_u32_u16 v78, v30, 1, v101
    v_mad_u32_u16 v79, v31, 1, v101
    s_mov_b64 exec, s[40:41]
    ds_read_b64 v[52:53], v76
    s_mov_b64 exec, s[42:43]
    ds_read_b64 v[54:55], v77
    s_mov_b64 exec, s[44:45]
    ds_read_b64 v[56:57], v78
    s_mov_b64 exec, s[46:47]
    ds_read_b64 v[58:59], v79
    s_mov_b64 exec, -1
    s_waitcnt lgkmcnt(0)
    v_lshlrev_b32 v80, 16, v32
    v_lshlrev_b32 v60, 16, v52
    v_and_b32 v61, v103, v52
    v_lshlrev_b32 v62, 16, v53
    v_and_b32 v63, v103, v53
    v_mul_f32 v60, v80, v60
    v_mul_f32 v61, v80, v61
    v_mul_f32 v62, v80, v62
    v_mul_f32 v63, v80, v63
    v_lshrrev_b32 v84, 16, v28
    s_mov_b64 exec, s[40:41]
    ds_add_f32 v84, v60
    ds_add_f32 v84, v61 offset:4
    ds_add_f32 v84, v62 offset:40000
    ds_add_f32 v84, v63 offset:40004
    s_mov_b64 exec, -1
    v_and_b32 v81, v103, v32
    v_lshlrev_b32 v64, 16, v54
    v_and_b32 v65, v103, v54
    v_lshlrev_b32 v66, 16, v55
    v_and_b32 v67, v103, v55
    v_mul_f32 v64, v81, v64
    v_mul_f32 v65, v81, v65
    v_mul_f32 v66, v81, v66
    v_mul_f32 v67, v81, v67
    v_lshrrev_b32 v85, 16, v29
    s_mov_b64 exec, s[42:43]
    ds_add_f32 v85, v64
    ds_add_f32 v85, v65 offset:4
    ds_add_f32 v85, v66 offset:40000
    ds_add_f32 v85, v67 offset:40004
    s_mov_b64 exec, -1
    v_lshlrev_b32 v82, 16, v33
    v_lshlrev_b32 v68, 16, v56
    v_and_b32 v69, v103, v56
    v_lshlrev_b32 v70, 16, v57
    v_and_b32 v71, v103, v57
    v_mul_f32 v68, v82, v68
    v_mul_f32 v69, v82, v69
    v_mul_f32 v70, v82, v70
    v_mul_f32 v71, v82, v71
    v_lshrrev_b32 v86, 16, v30
    s_mov_b64 exec, s[44:45]
    ds_add_f32 v86, v68
    ds_add_f32 v86, v69 offset:4
    ds_add_f32 v86, v70 offset:40000
    ds_add_f32 v86, v71 offset:40004
    s_mov_b64 exec, -1
    v_and_b32 v83, v103, v33
    v_lshlrev_b32 v72, 16, v58
    v_and_b32 v73, v103, v58
    v_lshlrev_b32 v74, 16, v59
    v_and_b32 v75, v103, v59
    v_mul_f32 v72, v83, v72
    v_mul_f32 v73, v83, v73
    v_mul_f32 v74, v83, v74
    v_mul_f32 v75, v83, v75
    v_lshrrev_b32 v87, 16, v31
    s_mov_b64 exec, s[46:47]
    ds_add_f32 v87, v72
    ds_add_f32 v87, v73 offset:4
    ds_add_f32 v87, v74 offset:40000
    ds_add_f32 v87, v75 offset:40004
    s_mov_b64 exec, -1
    s_waitcnt lgkmcnt(0)
    s_barrier
    s_add_u32 s85, s85, 1024
    s_branch k2_sw_209
k2_se_210:
    s_waitcnt vmcnt(0) lgkmcnt(0)
    s_barrier
    s_lshl_b32 s90, s84, 10
    s_mul_i32 s91, s86, 53760
    s_add_u32 m0, s90, 80000
    s_add_u32 s92, s91, 2150400
    buffer_load_dwordx4 v1, s[20:23], s92 offen lds
    s_add_u32 m0, s90, 96384
    s_add_u32 s92, s91, 2166784
    buffer_load_dwordx4 v1, s[20:23], s92 offen lds
    s_add_u32 m0, s90, 112768
    s_add_u32 s92, s91, 2183168
    buffer_load_dwordx4 v1, s[20:23], s92 offen lds
    s_cmp_ge_u32 s84, 5
    s_cbranch_scc1 k2_fill_217
    s_add_u32 m0, s90, 129152
    s_add_u32 s92, s91, 2199552
    buffer_load_dwordx4 v1, s[20:23], s92 offen lds
k2_fill_217:
    s_mov_b32 s85, 0
k2_sw_215:
    s_cmp_ge_u32 s85, s74
    s_cbranch_scc1 k2_se_216
    s_mov_b32 exec_lo, 0x0
    s_mov_b32 exec_hi, 0xffff0000
    v_lshrrev_b32 v96, 16, v3
    v_and_b32 v94, 0xffff, v3
    v_lshl_add_u32 v94, v94, 2, v19
    v_subrev_u32 v95, s85, v7
    v_lshlrev_b32 v95, 2, v95
k2_smap_218:
    v_cmpx_lt_i32 vcc, 0, v96
    s_cbranch_execz k2_smapd_219
    v_min_u32 v93, 4, v96
    v_add3_u32 v93, v93, v94, -1
    s_mov_b64 s[80:81], exec
    v_mov_b32 v97, 4096
    v_cmpx_lt_u32 vcc, v95, v97
    v_add_u32 v98, 134272, v95
    ds_write_b32 v98, v93
    s_mov_b64 exec, s[80:81]
    v_add_u32 v94, 16, v94
    v_add_u32 v95, 4, v95
    v_add_u32 v96, -4, v96
    s_branch k2_smap_218
k2_smapd_219:
    s_mov_b64 exec, -1
    s_waitcnt vmcnt(0) lgkmcnt(0)
    s_barrier
    s_mov_b32 s82, s74
    s_sub_u32 s74, s74, s85
    v_cmp_gt_u32 s[40:41], s74, v0
    v_add_u32 v91, 134272, v102
    ds_read_b32 v34, v91
    s_waitcnt lgkmcnt(0)
    s_mov_b64 s[42:43], 0
    s_mov_b64 s[44:45], 0
    s_mov_b64 s[46:47], 0
    s_mov_b64 exec, s[40:41]
    s_cbranch_execz k2_lr_220
    v_and_b32 v35, -4, v34
    buffer_load_dwordx4 v[28:31], v35, s[24:27], 0 offen
    v_lshrrev_b32 v35, 1, v35
    buffer_load_dwordx2 v[32:33], v35, s[76:79], 0 offen
    v_and_b32 v34, 3, v34
    v_cmp_le_u32 s[42:43], 1, v34
    v_cmp_le_u32 s[44:45], 2, v34
    v_cmp_le_u32 s[46:47], 3, v34
k2_lr_220:
    s_mov_b64 exec, -1
    s_mov_b32 s74, s82
    s_waitcnt vmcnt(0) lgkmcnt(0)
    v_mad_u32_u16 v76, v28, 1, v101
    v_mad_u32_u16 v77, v29, 1, v101
    v_mad_u32_u16 v78, v30, 1, v101
    v_mad_u32_u16 v79, v31, 1, v101
    s_mov_b64 exec, s[40:41]
    ds_read_b64 v[52:53], v76
    s_mov_b64 exec, s[42:43]
    ds_read_b64 v[54:55], v77
    s_mov_b64 exec, s[44:45]
    ds_read_b64 v[56:57], v78
    s_mov_b64 exec, s[46:47]
    ds_read_b64 v[58:59], v79
    s_mov_b64 exec, -1
    s_waitcnt lgkmcnt(0)
    v_lshlrev_b32 v80, 16, v32
    v_lshlrev_b32 v60, 16, v52
    v_and_b32 v61, v103, v52
    v_lshlrev_b32 v62, 16, v53
    v_and_b32 v63, v103, v53
    v_mul_f32 v60, v80, v60
    v_mul_f32 v61, v80, v61
    v_mul_f32 v62, v80, v62
    v_mul_f32 v63, v80, v63
    v_lshrrev_b32 v84, 16, v28
    s_mov_b64 exec, s[40:41]
    ds_add_f32 v84, v60
    ds_add_f32 v84, v61 offset:4
    ds_add_f32 v84, v62 offset:40000
    ds_add_f32 v84, v63 offset:40004
    s_mov_b64 exec, -1
    v_and_b32 v81, v103, v32
    v_lshlrev_b32 v64, 16, v54
    v_and_b32 v65, v103, v54
    v_lshlrev_b32 v66, 16, v55
    v_and_b32 v67, v103, v55
    v_mul_f32 v64, v81, v64
    v_mul_f32 v65, v81, v65
    v_mul_f32 v66, v81, v66
    v_mul_f32 v67, v81, v67
    v_lshrrev_b32 v85, 16, v29
    s_mov_b64 exec, s[42:43]
    ds_add_f32 v85, v64
    ds_add_f32 v85, v65 offset:4
    ds_add_f32 v85, v66 offset:40000
    ds_add_f32 v85, v67 offset:40004
    s_mov_b64 exec, -1
    v_lshlrev_b32 v82, 16, v33
    v_lshlrev_b32 v68, 16, v56
    v_and_b32 v69, v103, v56
    v_lshlrev_b32 v70, 16, v57
    v_and_b32 v71, v103, v57
    v_mul_f32 v68, v82, v68
    v_mul_f32 v69, v82, v69
    v_mul_f32 v70, v82, v70
    v_mul_f32 v71, v82, v71
    v_lshrrev_b32 v86, 16, v30
    s_mov_b64 exec, s[44:45]
    ds_add_f32 v86, v68
    ds_add_f32 v86, v69 offset:4
    ds_add_f32 v86, v70 offset:40000
    ds_add_f32 v86, v71 offset:40004
    s_mov_b64 exec, -1
    v_and_b32 v83, v103, v33
    v_lshlrev_b32 v72, 16, v58
    v_and_b32 v73, v103, v58
    v_lshlrev_b32 v74, 16, v59
    v_and_b32 v75, v103, v59
    v_mul_f32 v72, v83, v72
    v_mul_f32 v73, v83, v73
    v_mul_f32 v74, v83, v74
    v_mul_f32 v75, v83, v75
    v_lshrrev_b32 v87, 16, v31
    s_mov_b64 exec, s[46:47]
    ds_add_f32 v87, v72
    ds_add_f32 v87, v73 offset:4
    ds_add_f32 v87, v74 offset:40000
    ds_add_f32 v87, v75 offset:40004
    s_mov_b64 exec, -1
    s_waitcnt lgkmcnt(0)
    s_barrier
    s_add_u32 s85, s85, 1024
    s_branch k2_sw_215
k2_se_216:
    s_waitcnt vmcnt(0) lgkmcnt(0)
    s_barrier
    s_lshl_b32 s90, s84, 10
    s_mul_i32 s91, s86, 53760
    s_add_u32 m0, s90, 80000
    s_add_u32 s92, s91, 2365440
    buffer_load_dwordx4 v1, s[20:23], s92 offen lds
    s_add_u32 m0, s90, 96384
    s_add_u32 s92, s91, 2381824
    buffer_load_dwordx4 v1, s[20:23], s92 offen lds
    s_add_u32 m0, s90, 112768
    s_add_u32 s92, s91, 2398208
    buffer_load_dwordx4 v1, s[20:23], s92 offen lds
    s_cmp_ge_u32 s84, 5
    s_cbranch_scc1 k2_fill_223
    s_add_u32 m0, s90, 129152
    s_add_u32 s92, s91, 2414592
    buffer_load_dwordx4 v1, s[20:23], s92 offen lds
k2_fill_223:
    s_mov_b32 s85, 0
k2_sw_221:
    s_cmp_ge_u32 s85, s75
    s_cbranch_scc1 k2_se_222
    s_mov_b32 exec_lo, 0x0
    s_mov_b32 exec_hi, 0xffff0000
    v_lshrrev_b32 v96, 16, v4
    v_and_b32 v94, 0xffff, v4
    v_lshl_add_u32 v94, v94, 2, v19
    v_subrev_u32 v95, s85, v8
    v_lshlrev_b32 v95, 2, v95
k2_smap_224:
    v_cmpx_lt_i32 vcc, 0, v96
    s_cbranch_execz k2_smapd_225
    v_min_u32 v93, 4, v96
    v_add3_u32 v93, v93, v94, -1
    s_mov_b64 s[80:81], exec
    v_mov_b32 v97, 4096
    v_cmpx_lt_u32 vcc, v95, v97
    v_add_u32 v98, 134272, v95
    ds_write_b32 v98, v93
    s_mov_b64 exec, s[80:81]
    v_add_u32 v94, 16, v94
    v_add_u32 v95, 4, v95
    v_add_u32 v96, -4, v96
    s_branch k2_smap_224
k2_smapd_225:
    s_mov_b64 exec, -1
    s_waitcnt vmcnt(0) lgkmcnt(0)
    s_barrier
    s_mov_b32 s82, s75
    s_sub_u32 s75, s75, s85
    v_cmp_gt_u32 s[40:41], s75, v0
    v_add_u32 v91, 134272, v102
    ds_read_b32 v34, v91
    s_waitcnt lgkmcnt(0)
    s_mov_b64 s[42:43], 0
    s_mov_b64 s[44:45], 0
    s_mov_b64 s[46:47], 0
    s_mov_b64 exec, s[40:41]
    s_cbranch_execz k2_lr_226
    v_and_b32 v35, -4, v34
    buffer_load_dwordx4 v[28:31], v35, s[24:27], 0 offen
    v_lshrrev_b32 v35, 1, v35
    buffer_load_dwordx2 v[32:33], v35, s[76:79], 0 offen
    v_and_b32 v34, 3, v34
    v_cmp_le_u32 s[42:43], 1, v34
    v_cmp_le_u32 s[44:45], 2, v34
    v_cmp_le_u32 s[46:47], 3, v34
k2_lr_226:
    s_mov_b64 exec, -1
    s_mov_b32 s75, s82
    s_waitcnt vmcnt(0) lgkmcnt(0)
    v_mad_u32_u16 v76, v28, 1, v101
    v_mad_u32_u16 v77, v29, 1, v101
    v_mad_u32_u16 v78, v30, 1, v101
    v_mad_u32_u16 v79, v31, 1, v101
    s_mov_b64 exec, s[40:41]
    ds_read_b64 v[52:53], v76
    s_mov_b64 exec, s[42:43]
    ds_read_b64 v[54:55], v77
    s_mov_b64 exec, s[44:45]
    ds_read_b64 v[56:57], v78
    s_mov_b64 exec, s[46:47]
    ds_read_b64 v[58:59], v79
    s_mov_b64 exec, -1
    s_waitcnt lgkmcnt(0)
    v_lshlrev_b32 v80, 16, v32
    v_lshlrev_b32 v60, 16, v52
    v_and_b32 v61, v103, v52
    v_lshlrev_b32 v62, 16, v53
    v_and_b32 v63, v103, v53
    v_mul_f32 v60, v80, v60
    v_mul_f32 v61, v80, v61
    v_mul_f32 v62, v80, v62
    v_mul_f32 v63, v80, v63
    v_lshrrev_b32 v84, 16, v28
    s_mov_b64 exec, s[40:41]
    ds_add_f32 v84, v60
    ds_add_f32 v84, v61 offset:4
    ds_add_f32 v84, v62 offset:40000
    ds_add_f32 v84, v63 offset:40004
    s_mov_b64 exec, -1
    v_and_b32 v81, v103, v32
    v_lshlrev_b32 v64, 16, v54
    v_and_b32 v65, v103, v54
    v_lshlrev_b32 v66, 16, v55
    v_and_b32 v67, v103, v55
    v_mul_f32 v64, v81, v64
    v_mul_f32 v65, v81, v65
    v_mul_f32 v66, v81, v66
    v_mul_f32 v67, v81, v67
    v_lshrrev_b32 v85, 16, v29
    s_mov_b64 exec, s[42:43]
    ds_add_f32 v85, v64
    ds_add_f32 v85, v65 offset:4
    ds_add_f32 v85, v66 offset:40000
    ds_add_f32 v85, v67 offset:40004
    s_mov_b64 exec, -1
    v_lshlrev_b32 v82, 16, v33
    v_lshlrev_b32 v68, 16, v56
    v_and_b32 v69, v103, v56
    v_lshlrev_b32 v70, 16, v57
    v_and_b32 v71, v103, v57
    v_mul_f32 v68, v82, v68
    v_mul_f32 v69, v82, v69
    v_mul_f32 v70, v82, v70
    v_mul_f32 v71, v82, v71
    v_lshrrev_b32 v86, 16, v30
    s_mov_b64 exec, s[44:45]
    ds_add_f32 v86, v68
    ds_add_f32 v86, v69 offset:4
    ds_add_f32 v86, v70 offset:40000
    ds_add_f32 v86, v71 offset:40004
    s_mov_b64 exec, -1
    v_and_b32 v83, v103, v33
    v_lshlrev_b32 v72, 16, v58
    v_and_b32 v73, v103, v58
    v_lshlrev_b32 v74, 16, v59
    v_and_b32 v75, v103, v59
    v_mul_f32 v72, v83, v72
    v_mul_f32 v73, v83, v73
    v_mul_f32 v74, v83, v74
    v_mul_f32 v75, v83, v75
    v_lshrrev_b32 v87, 16, v31
    s_mov_b64 exec, s[46:47]
    ds_add_f32 v87, v72
    ds_add_f32 v87, v73 offset:4
    ds_add_f32 v87, v74 offset:40000
    ds_add_f32 v87, v75 offset:40004
    s_mov_b64 exec, -1
    s_waitcnt lgkmcnt(0)
    s_barrier
    s_add_u32 s85, s85, 1024
    s_branch k2_sw_221
k2_se_222:
    s_waitcnt vmcnt(0) lgkmcnt(0)
    s_barrier
    s_branch k2_epi
k2_end:
    s_endpgm
.section .rodata,"a"
.p2align 6
.amdhsa_kernel k1_kernel
  .amdhsa_next_free_vgpr 128
  .amdhsa_next_free_sgpr 102
  .amdhsa_accum_offset 128
  .amdhsa_group_segment_fixed_size 0
  .amdhsa_kernarg_size 112
  .amdhsa_user_sgpr_count 2
  .amdhsa_user_sgpr_kernarg_segment_ptr 1
  .amdhsa_system_sgpr_workgroup_id_x 1
  .amdhsa_float_denorm_mode_32 3
  .amdhsa_float_denorm_mode_16_64 3
.end_amdhsa_kernel
.p2align 6
.amdhsa_kernel k2_kernel
  .amdhsa_next_free_vgpr 128
  .amdhsa_next_free_sgpr 102
  .amdhsa_accum_offset 128
  .amdhsa_group_segment_fixed_size 0
  .amdhsa_kernarg_size 112
  .amdhsa_user_sgpr_count 2
  .amdhsa_user_sgpr_kernarg_segment_ptr 1
  .amdhsa_system_sgpr_workgroup_id_x 1
  .amdhsa_float_denorm_mode_32 3
  .amdhsa_float_denorm_mode_16_64 3
.end_amdhsa_kernel
```
